```python
import torch

def _softmax(x, axis=-1):
    return torch.softmax(x, dim=axis)
def _gelu(x):
    return torch.nn.functional.gelu(x, approximate="tanh")
def _silu(x):
    return torch.nn.functional.silu(x)
def _sigmoid(x):
    return torch.sigmoid(x)
def _layernorm(x, axis=-1, eps=1e-5):
    m = x.mean(dim=axis, keepdim=True)
    v = x.var(dim=axis, keepdim=True, unbiased=False)
    return (x - m) / torch.sqrt(v + eps)
def _scatter_add(tgt, idx, src, axis=0):
    return tgt.clone().index_add_(axis, idx, src)
def _segment_sum(src, seg, n):
    out = torch.zeros((n,) + src.shape[1:], dtype=src.dtype)
    return out.index_add_(0, seg, src)
def _pad(x, pw):
    flat = tuple(v for pair in reversed(pw) for v in pair)
    return torch.nn.functional.pad(x, flat)

kernel_name = 'parallel_sum__gqa_block_cached__mixer_token_mlp__decode'

def setup_inputs():

    _w = (lambda a: (lambda t: t.to(torch.bfloat16) if t.is_floating_point() else t)(torch.as_tensor(a)))
    def _A_setup():
        B, Sq, D = 1, 1, 512
        Hq, Hkv, Sk, Dh = 32, 8, 32768, 128
        assert Hq % Hkv == 0, (Hq, Hkv)
        return {
            "x": _w((lambda *s: torch.randn(*s, dtype=torch.bfloat16) * 0.05)(B, Sq, D)),
            "k_cache": _w((lambda *s: torch.randn(*s, dtype=torch.bfloat16) * 3.2)(B, Hkv, Sk, Dh)),
            "v_cache": _w((lambda *s: torch.randn(*s, dtype=torch.bfloat16) * 1.6)(B, Hkv, Sk, Dh)),
            "wq": _w((lambda *s: torch.randn(*s, dtype=torch.bfloat16) * 3.2)(D, Hq * Dh) * (D ** -0.5)),
            "wo": _w((lambda *s: torch.randn(*s, dtype=torch.bfloat16) * 1.6)(Hq * Dh, D) * ((Hq * Dh) ** -0.5)),
        }
    _A_in = _A_setup()

    def _B_setup():
        B, S, D, F = 1, 1, 512, 1792
        return {
            "x": _w((lambda *s: torch.randn(*s, dtype=torch.bfloat16) * 0.05)(B, S, D)),
            "w1": _w((lambda *s: torch.randn(*s, dtype=torch.bfloat16) * 1.6)(S, F) * (S ** -0.5)),
            "b1": _w((lambda *s: torch.randn(*s, dtype=torch.bfloat16) * 1.6)(F) * 0.02),
            "w2": _w((lambda *s: torch.randn(*s, dtype=torch.bfloat16) * 1.6)(F, S) * (F ** -0.5)),
            "b2": _w((lambda *s: torch.randn(*s, dtype=torch.bfloat16) * 1.6)(S) * 0.02),
        }
    _B_in = _B_setup()

    return {
        "A_x": _A_in["x"],
        "A_k_cache": _A_in["k_cache"],
        "A_v_cache": _A_in["v_cache"],
        "A_wq": _A_in["wq"],
        "A_wo": _A_in["wo"],
        "B_x": _B_in["x"],
        "B_w1": _B_in["w1"],
        "B_b1": _B_in["b1"],
        "B_w2": _B_in["w2"],
        "B_b2": _B_in["b2"],
    }

def reference(A_x, A_k_cache, A_v_cache, A_wq, A_wo, B_x, B_w1, B_b1, B_w2, B_b2):
    def _A_ref(x, k_cache, v_cache, wq, wo):
        B, Sq, D = x.shape
        Hq, Dh = 32, 128
        Hkv = k_cache.shape[1]
        rep = Hq // Hkv
        q = (lambda x, *d: x.permute(*d))((x @ wq).reshape(B, Sq, Hq, Dh), 0, 2, 1, 3)
        k = (lambda x, n, axis: torch.repeat_interleave(x, n, dim=axis))(k_cache, rep, axis=1)
        v = (lambda x, n, axis: torch.repeat_interleave(x, n, dim=axis))(v_cache, rep, axis=1)
        scores = torch.einsum("bhqd,bhkd->bhqk", q, k) * (Dh ** -0.5)
        p = _softmax(scores, axis=-1)
        o = torch.einsum("bhqk,bhkd->bhqd", p, v)
        return (lambda x, *d: x.permute(*d))(o, 0, 2, 1, 3).reshape(B, Sq, Hq * Dh) @ wo

    def _B_ref(x, w1, b1, w2, b2):
        B, S, D = x.shape
        h = _layernorm(x, axis=-1)
        u = torch.einsum("bsd,sf->bdf", h, w1) + b1
        u = _gelu(u)
        y = torch.einsum("bdf,fs->bds", u, w2) + b2
        return (lambda x, *d: x.permute(*d))(y, 0, 2, 1)

    x = A_x
    xn = _layernorm(x, axis=-1)
    return x + _A_ref(xn, A_k_cache, A_v_cache, A_wq, A_wo) + _B_ref(xn, B_w1, B_b1, B_w2, B_b2)
```

```asm
; @launch grid=(256,1,1) block=(256,1,1) lds=150016
.amdgcn_target "amdgcn-amd-amdhsa--gfx950"
.text
.globl parallel_sum__gqa_block_cached__mixer_token_mlp__decode_kernel
.p2align 14
.p2align 8
.type parallel_sum__gqa_block_cached__mixer_token_mlp__decode_kernel,@function
parallel_sum__gqa_block_cached__mixer_token_mlp__decode_kernel:
  s_cmp_lt_u32 s2, 256
  s_cbranch_scc1 L_go
  s_endpgm
L_go:
  s_load_dwordx16 s[4:19], s[0:1], 0
  s_load_dwordx8 s[20:27], s[0:1], 64
  s_load_dwordx2 s[28:29], s[0:1], 96
  v_lshrrev_b32 v32, 6, v0
  v_and_b32 v1, 63, v0
  v_readfirstlane_b32 s3, v32
  s_getpc_b64 s[76:77]
L_pc:
  s_lshr_b32 s69, s2, 3
  s_and_b32 s69, s69, 3
  s_lshl_b32 s69, s69, 2
  s_add_u32 s69, s69, s3
  s_lshl_b32 s69, s69, 10
  v_and_b32 v33, 7, v0
  v_lshlrev_b32 v33, 7, v33
  v_add_u32 v33, s69, v33
  v_min_u32 v33, L_codeend-L_pc-4, v33
  global_load_dword v30, v33, s[76:77]
  s_and_b32 s64, s2, 7
  s_lshr_b32 s65, s2, 3
  s_lshl_b32 s66, s64, 5
  s_add_u32 s66, s66, s65
  s_lshr_b32 s70, s65, 3
  s_lshl_b32 s70, s70, 2
  s_add_u32 s70, s70, s3
  s_lshl_b32 s70, s70, 18
  s_lshl_b32 s73, s64, 2
  s_and_b32 s71, s65, 7
  s_lshl_b32 s71, s71, 7
  s_add_u32 s31, s70, s71
  s_lshr_b32 s72, 0xf6f4f2f0, s73
  s_and_b32 s72, s72, 15
  s_lshl_b32 s72, s72, 10
  s_add_u32 s70, s31, s72
  s_mov_b32 s67, s66
  v_and_b32 v34, 15, v1
  v_lshrrev_b32 v35, 4, v1
  v_xor_b32 v36, v34, v35
  v_lshlrev_b32 v36, 4, v36
  v_lshl_add_u32 v8, v35, 8, v36
  v_xor_b32 v9, 0x40, v8
  v_xor_b32 v10, 0x80, v8
  v_xor_b32 v11, 0xc0, v8
  v_lshrrev_b32 v37, 3, v1
  v_lshlrev_b32 v37, 13, v37
  v_and_b32 v38, 7, v1
  v_lshl_add_u32 v37, v38, 4, v37
  v_lshlrev_b32 v38, 4, v1
  v_mov_b32 v39, 0
  s_lshl_b32 s69, s67, 18
  s_lshl_b32 s71, s3, 12
  s_add_u32 s69, s69, s71
  s_lshl_b32 s68, s3, 15
  s_lshl_b32 s71, s3, 12
  s_add_u32 m0, s71, 131072
  s_mov_b32 s42, 0x3e080
  s_mov_b32 s43, 0x20000
  s_mov_b32 s34, 0x3d000
  s_mov_b32 s35, 0x20000
  s_waitcnt lgkmcnt(0)
  global_load_dwordx4 v[40:43], v38, s[4:5]
  s_load_dword s14, s[28:29], 0
  s_add_u32 s40, s10, s70
  s_addc_u32 s41, s11, 0
  s_add_u32 s32, s6, s69
  s_addc_u32 s33, s7, 0
  s_cmp_lg_u32 s72, 0x3c00
  s_cbranch_scc1 L_a0
  global_load_dword v30, v39, s[4:5]
  global_load_dword v30, v39, s[4:5]
  global_load_dword v30, v39, s[4:5]
  global_load_dword v30, v39, s[4:5]
  s_branch L_a1
L_a0:
  buffer_load_dwordx4 v37, s[40:43], 0 offen offset:0 nt lds
  s_mov_b32 s72, 0xfc00
  buffer_load_dwordx4 v37, s[40:43], s72 offen offset:1024 nt lds
  s_mov_b32 s72, 0x1f800
  buffer_load_dwordx4 v37, s[40:43], s72 offen offset:2048 nt lds
  s_mov_b32 s72, 0x2f400
  buffer_load_dwordx4 v37, s[40:43], s72 offen offset:3072 nt lds
  s_lshr_b32 s71, 0xf7f5f3f1, s73
  s_and_b32 s71, s71, 15
  s_cmp_eq_u32 s71, 15
  s_cbranch_scc1 L_a1
  s_lshl_b32 s71, s71, 10
  s_add_u32 s71, s71, s31
  s_add_u32 s40, s10, s71
  s_addc_u32 s41, s11, 0
  s_add_u32 m0, s68, 24576
  s_nop 0
  buffer_load_dwordx4 v37, s[40:43], 0 offen offset:0 nt lds
  s_mov_b32 s72, 0xfc00
  buffer_load_dwordx4 v37, s[40:43], s72 offen offset:1024 nt lds
  s_mov_b32 s72, 0x1f800
  buffer_load_dwordx4 v37, s[40:43], s72 offen offset:2048 nt lds
  s_mov_b32 s72, 0x2f400
  buffer_load_dwordx4 v37, s[40:43], s72 offen offset:3072 nt lds
L_a1:
  s_add_u32 m0, s68, 0
  s_mov_b32 s72, 0x0
  buffer_load_dwordx4 v8, s[32:35], s72 offen offset:0 nt lds
  buffer_load_dwordx4 v9, s[32:35], s72 offen offset:1024 nt lds
  buffer_load_dwordx4 v10, s[32:35], s72 offen offset:2048 nt lds
  buffer_load_dwordx4 v11, s[32:35], s72 offen offset:3072 nt lds
  s_getreg_b32 s30, hwreg(HW_REG_XCC_ID, 0, 4)
  s_mov_b32 s38, 0x3d000
  s_mov_b32 s39, 0x20000
  s_add_u32 s36, s8, s69
  s_addc_u32 s37, s9, 0
  v_lshlrev_b32 v3, 4, v0
  v_lshlrev_b32 v4, 2, v1
  s_mov_b32 s52, s16
  s_mov_b32 s53, s17
  s_mov_b32 s54, 3584
  s_mov_b32 s55, 0x20000
  s_mov_b32 s56, s18
  s_mov_b32 s57, s19
  s_mov_b32 s58, 3584
  s_mov_b32 s59, 0x20000
  s_mov_b32 s60, s20
  s_mov_b32 s61, s21
  s_mov_b32 s62, 3584
  s_mov_b32 s63, 0x20000
  s_lshl_b32 s70, s66, 2
  v_mov_b32 v28, s70
  buffer_load_dwordx4 v[52:55], v3, s[52:55], 0 offen
  buffer_load_dwordx4 v[56:59], v3, s[56:59], 0 offen
  buffer_load_dwordx4 v[60:63], v3, s[60:63], 0 offen
  global_load_ushort v29, v39, s[22:23]
  global_load_dword v28, v28, s[4:5]
  s_mov_b32 s48, s28
  s_mov_b32 s49, s29
  s_mov_b32 s50, 0x400000
  s_mov_b32 s51, 0x20000
  s_and_b32 s70, s67, 0xfc
  s_add_u32 s70, s70, s3
  s_lshl_b32 s70, s70, 14
  s_and_b32 s71, s67, 3
  s_lshl_b32 s71, s71, 8
  s_add_u32 s70, s70, s71
  s_add_u32 s44, s12, s70
  s_addc_u32 s45, s13, 0
  s_mov_b32 s46, 15616
  s_mov_b32 s47, 0x20000
  v_lshlrev_b32 v16, 4, v34
  v_lshl_add_u32 v16, v35, 10, v16
  v_lshl_add_u32 v12, v34, 8, v36
  v_add_u32 v12, s68, v12
  v_xor_b32 v13, 0x40, v12
  v_xor_b32 v14, 0x80, v12
  v_xor_b32 v15, 0xc0, v12
  v_and_b32 v32, 3, v1
  v_bfe_u32 v33, v1, 2, 2
  s_lshl_b32 s70, s3, 5
  s_add_u32 s70, s70, 131072
  v_lshlrev_b32 v216, 3, v32
  v_lshl_add_u32 v216, v33, 7, v216
  v_lshl_add_u32 v216, v35, 10, v216
  v_add_u32 v216, s70, v216
  s_lshr_b32 s70, s66, 3
  s_and_b32 s70, s70, 3
  s_lshl_b32 s71, s70, 8
  s_add_u32 s71, s71, 147456
  v_lshlrev_b32 v217, 4, v35
  v_add_u32 v217, s71, v217
  v_add_u32 v218, 147456, v38
  s_lshl_b32 s75, s70, 12
  s_and_b32 s71, s66, 7
  s_lshl_b32 s71, s71, 2
  s_add_u32 s71, s71, s3
  s_lshl_b32 s71, s71, 7
  s_add_u32 s75, s75, s71
  s_add_u32 s75, s75, 0x10000
  v_and_b32 v219, 1, v1
  v_lshl_add_u32 v219, v35, 1, v219
  v_lshlrev_b32 v219, 4, v219
  v_lshlrev_b32 v220, 8, v33
  v_lshl_add_u32 v220, v35, 4, v220
  v_add_u32 v220, 148480, v220
  s_lshl_b32 s74, s64, 14
  s_add_u32 s74, s74, 0x10000
  s_mov_b32 s78, 0x0c0c0c0c
  v_mov_b32 v20, s78
  v_mov_b32 v33, 0x0c0c0100
  v_cmp_eq_u32 vcc, 0, v32
  s_nop 1
  v_cndmask_b32 v20, v20, v33, vcc
  v_mov_b32 v33, 0x01000c0c
  v_cmp_eq_u32 vcc, 1, v32
  s_nop 1
  v_cndmask_b32 v20, v20, v33, vcc
  v_mov_b32 v21, s78
  v_mov_b32 v33, 0x0c0c0100
  v_cmp_eq_u32 vcc, 2, v32
  s_nop 1
  v_cndmask_b32 v21, v21, v33, vcc
  v_mov_b32 v33, 0x01000c0c
  v_cmp_eq_u32 vcc, 3, v32
  s_nop 1
  v_cndmask_b32 v21, v21, v33, vcc
  v_mov_b32 v22, s78
  v_mov_b32 v33, 0x0c0c0302
  v_cmp_eq_u32 vcc, 0, v32
  s_nop 1
  v_cndmask_b32 v22, v22, v33, vcc
  v_mov_b32 v33, 0x03020c0c
  v_cmp_eq_u32 vcc, 1, v32
  s_nop 1
  v_cndmask_b32 v22, v22, v33, vcc
  v_mov_b32 v23, s78
  v_mov_b32 v33, 0x0c0c0302
  v_cmp_eq_u32 vcc, 2, v32
  s_nop 1
  v_cndmask_b32 v23, v23, v33, vcc
  v_mov_b32 v33, 0x03020c0c
  v_cmp_eq_u32 vcc, 3, v32
  s_nop 1
  v_cndmask_b32 v23, v23, v33, vcc
  s_waitcnt vmcnt(13)
  s_waitcnt lgkmcnt(0)
  v_mov_b32 v2, s14
  s_mov_b32 s78, 1664525
  v_mul_lo_u32 v2, v2, s78
  v_add_u32 v2, 1013904223, v2
  v_lshlrev_b32 v44, 16, v40
  v_and_b32 v45, 0xffff0000, v40
  v_lshlrev_b32 v46, 16, v41
  v_and_b32 v47, 0xffff0000, v41
  v_lshlrev_b32 v48, 16, v42
  v_and_b32 v49, 0xffff0000, v42
  v_lshlrev_b32 v50, 16, v43
  v_and_b32 v51, 0xffff0000, v43
  v_add_f32 v104, v44, v45
  v_add_f32 v105, v46, v47
  v_add_f32 v106, v48, v49
  v_add_f32 v107, v50, v51
  v_add_f32 v104, v104, v105
  v_add_f32 v106, v106, v107
  v_add_f32 v112, v104, v106
  s_nop 1
  v_add_f32_dpp v112, v112, v112 row_ror:1 row_mask:0xf bank_mask:0xf
  s_nop 1
  v_add_f32_dpp v112, v112, v112 row_ror:2 row_mask:0xf bank_mask:0xf
  s_nop 1
  v_add_f32_dpp v112, v112, v112 row_ror:4 row_mask:0xf bank_mask:0xf
  s_nop 1
  v_add_f32_dpp v112, v112, v112 row_ror:8 row_mask:0xf bank_mask:0xf
  v_mov_b32 v113, v112
  s_nop 1
  v_permlane16_swap_b32 v112, v113
  v_add_f32 v112, v112, v113
  v_mov_b32 v113, v112
  s_nop 1
  v_permlane32_swap_b32 v112, v113
  v_add_f32 v112, v112, v113
  v_mul_f32 v112, 0x3b000000, v112
  v_sub_f32 v104, v44, v112
  v_sub_f32 v105, v45, v112
  v_sub_f32 v106, v46, v112
  v_sub_f32 v107, v47, v112
  v_sub_f32 v108, v48, v112
  v_sub_f32 v109, v49, v112
  v_sub_f32 v110, v50, v112
  v_sub_f32 v111, v51, v112
  v_cvt_pk_bf16_f32 v112, 0, v112
  v_mul_f32 v104, v104, v104
  v_mul_f32 v105, v105, v105
  v_fmac_f32 v104, v106, v106
  v_fmac_f32 v105, v107, v107
  v_fmac_f32 v104, v108, v108
  v_fmac_f32 v105, v109, v109
  v_fmac_f32 v104, v110, v110
  v_fmac_f32 v105, v111, v111
  v_add_f32 v104, v104, v105
  s_nop 1
  v_add_f32_dpp v104, v104, v104 row_ror:1 row_mask:0xf bank_mask:0xf
  s_nop 1
  v_add_f32_dpp v104, v104, v104 row_ror:2 row_mask:0xf bank_mask:0xf
  s_nop 1
  v_add_f32_dpp v104, v104, v104 row_ror:4 row_mask:0xf bank_mask:0xf
  s_nop 1
  v_add_f32_dpp v104, v104, v104 row_ror:8 row_mask:0xf bank_mask:0xf
  v_mov_b32 v113, v104
  s_nop 1
  v_permlane16_swap_b32 v104, v113
  v_add_f32 v104, v104, v113
  v_mov_b32 v113, v104
  s_nop 1
  v_permlane32_swap_b32 v104, v113
  v_add_f32 v104, v104, v113
  v_mul_f32 v104, 0x3b000000, v104
  v_cvt_pk_bf16_f32 v104, 0, v104
  v_add_f32 v104, 0x3727c5ac, v104
  v_cvt_pk_bf16_f32 v104, 0, v104
  v_sqrt_f32 v104, v104
  s_nop 0
  v_cvt_pk_bf16_f32 v104, 0, v104
  v_rcp_f32 v104, v104
  v_sub_f32 v44, v44, v112
  v_sub_f32 v45, v45, v112
  v_sub_f32 v46, v46, v112
  v_sub_f32 v47, v47, v112
  v_sub_f32 v48, v48, v112
  v_sub_f32 v49, v49, v112
  v_sub_f32 v50, v50, v112
  v_sub_f32 v51, v51, v112
  v_cvt_pk_bf16_f32 v44, 0, v44
  v_cvt_pk_bf16_f32 v45, 0, v45
  v_cvt_pk_bf16_f32 v46, 0, v46
  v_cvt_pk_bf16_f32 v47, 0, v47
  v_cvt_pk_bf16_f32 v48, 0, v48
  v_cvt_pk_bf16_f32 v49, 0, v49
  v_cvt_pk_bf16_f32 v50, 0, v50
  v_cvt_pk_bf16_f32 v51, 0, v51
  v_mul_f32 v44, v44, v104
  v_mul_f32 v45, v45, v104
  v_mul_f32 v46, v46, v104
  v_mul_f32 v47, v47, v104
  v_mul_f32 v48, v48, v104
  v_mul_f32 v49, v49, v104
  v_mul_f32 v50, v50, v104
  v_mul_f32 v51, v51, v104
  v_cvt_pk_bf16_f32 v40, v44, v45
  v_cvt_pk_bf16_f32 v41, v46, v47
  v_cvt_pk_bf16_f32 v42, v48, v49
  v_cvt_pk_bf16_f32 v43, v50, v51
  ds_write_b128 v218, v[40:43]
  s_waitcnt vmcnt(9)
  s_add_u32 m0, s68, 4096
  s_mov_b32 s72, 0x4000
  buffer_load_dwordx4 v8, s[32:35], s72 offen offset:0 nt lds
  buffer_load_dwordx4 v9, s[32:35], s72 offen offset:1024 nt lds
  buffer_load_dwordx4 v10, s[32:35], s72 offen offset:2048 nt lds
  buffer_load_dwordx4 v11, s[32:35], s72 offen offset:3072 nt lds
  s_waitcnt lgkmcnt(0)
  s_barrier
  ds_read_b128 v[120:123], v217 offset:0
  ds_read_b128 v[124:127], v217 offset:64
  ds_read_b128 v[128:131], v217 offset:128
  ds_read_b128 v[132:135], v217 offset:192
  s_mov_b32 vcc_lo, 0xaaaaaaaa
  s_mov_b32 vcc_hi, 0xaaaaaaaa
  v_mov_b32 v207, s30
  s_lshr_b32 s70, 0xf6f4f2f0, s73
  s_and_b32 s70, s70, 15
  s_cmp_eq_u32 s70, 15
  s_cbranch_scc0 L_q0a
  v_mov_b32 v32, 0x7ff00000
  buffer_store_dword v32, v32, s[48:51], 0 offen
  s_branch L_q0b
L_q0a:
  ds_read_b64_tr_b16 v[104:105], v216 offset:0
  ds_read_b64_tr_b16 v[106:107], v216 offset:512
  ds_read_b64_tr_b16 v[108:109], v216 offset:4096
  ds_read_b64_tr_b16 v[110:111], v216 offset:4608
  ds_read_b64_tr_b16 v[112:113], v216 offset:8192
  ds_read_b64_tr_b16 v[114:115], v216 offset:8704
  ds_read_b64_tr_b16 v[116:117], v216 offset:12288
  ds_read_b64_tr_b16 v[118:119], v216 offset:12800
  s_lshl_b32 s70, s70, 14
  s_add_u32 s70, s70, s75
  s_waitcnt lgkmcnt(6)
  v_mfma_f32_16x16x32_bf16 v[200:203], v[104:107], v[120:123], 0
  s_waitcnt lgkmcnt(4)
  v_mfma_f32_16x16x32_bf16 v[200:203], v[108:111], v[124:127], v[200:203]
  s_waitcnt lgkmcnt(2)
  v_mfma_f32_16x16x32_bf16 v[200:203], v[112:115], v[128:131], v[200:203]
  s_waitcnt lgkmcnt(0)
  v_mfma_f32_16x16x32_bf16 v[200:203], v[116:119], v[132:135], v[200:203]
  s_nop 7
  v_cndmask_b32 v204, v200, v202, vcc
  v_cndmask_b32 v205, v201, v203, vcc
  v_bitop3_b32 v206, v204, v205, v2 bitop3:0x96
  v_xor_b32 v206, v206, v207
  s_mov_b32 exec_lo, 0x00030003
  s_mov_b32 exec_hi, 0x00030003
  buffer_store_dwordx4 v[204:207], v219, s[48:51], s70 offen sc1
  s_mov_b64 exec, -1
  s_nop 1
L_q0b:
  s_lshr_b32 s70, 0xf7f5f3f1, s73
  s_and_b32 s70, s70, 15
  s_cmp_eq_u32 s70, 15
  s_cbranch_scc0 L_q1a
  v_mov_b32 v32, 0x7ff00000
  buffer_store_dword v32, v32, s[48:51], 0 offen
  s_branch L_q1b
L_q1a:
  v_add_u32 v32, 0xfffe6000, v216
  v_add_u32 v33, 0x10000, v32
  ds_read_b64_tr_b16 v[104:105], v32 offset:0
  ds_read_b64_tr_b16 v[106:107], v32 offset:512
  ds_read_b64_tr_b16 v[108:109], v32 offset:32768
  ds_read_b64_tr_b16 v[110:111], v32 offset:33280
  ds_read_b64_tr_b16 v[112:113], v33 offset:0
  ds_read_b64_tr_b16 v[114:115], v33 offset:512
  ds_read_b64_tr_b16 v[116:117], v33 offset:32768
  ds_read_b64_tr_b16 v[118:119], v33 offset:33280
  s_lshl_b32 s70, s70, 14
  s_add_u32 s70, s70, s75
  s_waitcnt lgkmcnt(6)
  v_mfma_f32_16x16x32_bf16 v[200:203], v[104:107], v[120:123], 0
  s_waitcnt lgkmcnt(4)
  v_mfma_f32_16x16x32_bf16 v[200:203], v[108:111], v[124:127], v[200:203]
  s_waitcnt lgkmcnt(2)
  v_mfma_f32_16x16x32_bf16 v[200:203], v[112:115], v[128:131], v[200:203]
  s_waitcnt lgkmcnt(0)
  v_mfma_f32_16x16x32_bf16 v[200:203], v[116:119], v[132:135], v[200:203]
  s_nop 7
  v_cndmask_b32 v204, v200, v202, vcc
  v_cndmask_b32 v205, v201, v203, vcc
  v_bitop3_b32 v206, v204, v205, v2 bitop3:0x96
  v_xor_b32 v206, v206, v207
  s_mov_b32 exec_lo, 0x00030003
  s_mov_b32 exec_hi, 0x00030003
  buffer_store_dwordx4 v[204:207], v219, s[48:51], s70 offen sc1
  s_mov_b64 exec, -1
  s_nop 1
L_q1b:
  s_waitcnt lgkmcnt(0)
  s_barrier
  s_lshl_b32 s70, s66, 3
  s_add_u32 s70, s70, 0x8000
  s_cmp_eq_u32 s3, 0
  s_cselect_b32 s70, s70, 0x7ff00000
  v_mov_b32 v32, s70
  v_mov_b32 v200, s30
  v_xor_b32 v201, s30, v2
  s_mov_b64 exec, 1
  buffer_store_dwordx2 v[200:201], v32, s[48:51], 0 offen sc1
  s_mov_b64 exec, -1
  s_waitcnt vmcnt(12)
  s_add_u32 m0, s68, 8192
  s_mov_b32 s72, 0x8000
  buffer_load_dwordx4 v8, s[32:35], s72 offen offset:0 nt lds
  buffer_load_dwordx4 v9, s[32:35], s72 offen offset:1024 nt lds
  buffer_load_dwordx4 v10, s[32:35], s72 offen offset:2048 nt lds
  buffer_load_dwordx4 v11, s[32:35], s72 offen offset:3072 nt lds
  s_waitcnt vmcnt(11)
  v_lshlrev_b32 v44, 16, v40
  v_and_b32 v45, 0xffff0000, v40
  v_lshlrev_b32 v46, 16, v41
  v_and_b32 v47, 0xffff0000, v41
  v_lshlrev_b32 v48, 16, v42
  v_and_b32 v49, 0xffff0000, v42
  v_lshlrev_b32 v50, 16, v43
  v_and_b32 v51, 0xffff0000, v43
  s_lshl_b32 s70, s66, 2
  s_add_u32 s70, s70, 147456
  v_mov_b32 v64, s70
  ds_read_b32 v66, v64
  v_add_f32 v104, v44, v45
  v_add_f32 v105, v46, v47
  v_add_f32 v106, v48, v49
  v_add_f32 v107, v50, v51
  v_add_f32 v104, v104, v105
  v_add_f32 v106, v106, v107
  v_add_f32 v112, v104, v106
  s_nop 1
  v_add_f32_dpp v112, v112, v112 row_ror:1 row_mask:0xf bank_mask:0xf
  s_nop 1
  v_add_f32_dpp v112, v112, v112 row_ror:2 row_mask:0xf bank_mask:0xf
  s_nop 1
  v_add_f32_dpp v112, v112, v112 row_ror:4 row_mask:0xf bank_mask:0xf
  s_nop 1
  v_add_f32_dpp v112, v112, v112 row_ror:8 row_mask:0xf bank_mask:0xf
  v_mov_b32 v113, v112
  s_nop 1
  v_permlane16_swap_b32 v112, v113
  v_add_f32 v112, v112, v113
  v_mov_b32 v113, v112
  s_nop 1
  v_permlane32_swap_b32 v112, v113
  v_add_f32 v112, v112, v113
  v_mul_f32 v112, 0x3b000000, v112
  v_sub_f32 v104, v44, v112
  v_sub_f32 v105, v45, v112
  v_sub_f32 v106, v46, v112
  v_sub_f32 v107, v47, v112
  v_sub_f32 v108, v48, v112
  v_sub_f32 v109, v49, v112
  v_sub_f32 v110, v50, v112
  v_sub_f32 v111, v51, v112
  v_cvt_pk_bf16_f32 v112, 0, v112
  v_mul_f32 v104, v104, v104
  v_mul_f32 v105, v105, v105
  v_fmac_f32 v104, v106, v106
  v_fmac_f32 v105, v107, v107
  v_fmac_f32 v104, v108, v108
  v_fmac_f32 v105, v109, v109
  v_fmac_f32 v104, v110, v110
  v_fmac_f32 v105, v111, v111
  v_add_f32 v104, v104, v105
  s_nop 1
  v_add_f32_dpp v104, v104, v104 row_ror:1 row_mask:0xf bank_mask:0xf
  s_nop 1
  v_add_f32_dpp v104, v104, v104 row_ror:2 row_mask:0xf bank_mask:0xf
  s_nop 1
  v_add_f32_dpp v104, v104, v104 row_ror:4 row_mask:0xf bank_mask:0xf
  s_nop 1
  v_add_f32_dpp v104, v104, v104 row_ror:8 row_mask:0xf bank_mask:0xf
  v_mov_b32 v113, v104
  s_nop 1
  v_permlane16_swap_b32 v104, v113
  v_add_f32 v104, v104, v113
  v_mov_b32 v113, v104
  s_nop 1
  v_permlane32_swap_b32 v104, v113
  v_add_f32 v104, v104, v113
  v_mul_f32 v104, 0x3b000000, v104
  v_cvt_pk_bf16_f32 v104, 0, v104
  v_add_f32 v104, 0x3727c5ac, v104
  v_cvt_pk_bf16_f32 v104, 0, v104
  v_sqrt_f32 v104, v104
  s_nop 0
  v_cvt_pk_bf16_f32 v104, 0, v104
  v_rcp_f32 v104, v104
  s_waitcnt lgkmcnt(0)
  v_lshlrev_b32 v64, 16, v66
  v_and_b32 v65, 0xffff0000, v66
  v_sub_f32 v64, v64, v112
  v_sub_f32 v65, v65, v112
  v_cvt_pk_bf16_f32 v64, 0, v64
  v_cvt_pk_bf16_f32 v65, 0, v65
  v_mul_f32 v64, v64, v104
  v_mul_f32 v65, v65, v104
  v_cvt_pk_bf16_f32 v64, 0, v64
  v_cvt_pk_bf16_f32 v65, 0, v65
  v_mov_b32 v26, 0
  v_mov_b32 v27, 0
  s_waitcnt vmcnt(7)
  s_add_u32 m0, s68, 12288
  s_mov_b32 s72, 0xc000
  buffer_load_dwordx4 v8, s[32:35], s72 offen offset:0 nt lds
  buffer_load_dwordx4 v9, s[32:35], s72 offen offset:1024 nt lds
  buffer_load_dwordx4 v10, s[32:35], s72 offen offset:2048 nt lds
  buffer_load_dwordx4 v11, s[32:35], s72 offen offset:3072 nt lds
  v_lshlrev_b32 v104, 16, v52
  v_and_b32 v105, 0xffff0000, v52
  v_lshlrev_b32 v106, 16, v56
  v_and_b32 v107, 0xffff0000, v56
  s_mov_b32 s78, 0xc0135761
  v_mov_b32 v116, 0xbdd2d3e8
  v_mul_f32 v108, v64, v104
  v_mul_f32 v109, v64, v105
  v_mul_f32 v110, v65, v104
  v_mul_f32 v111, v65, v105
  v_cvt_pk_bf16_f32 v108, 0, v108
  v_cvt_pk_bf16_f32 v109, 0, v109
  v_cvt_pk_bf16_f32 v110, 0, v110
  v_cvt_pk_bf16_f32 v111, 0, v111
  v_add_f32 v108, v108, v106
  v_add_f32 v109, v109, v107
  v_add_f32 v110, v110, v106
  v_add_f32 v111, v111, v107
  v_cvt_pk_bf16_f32 v108, 0, v108
  v_cvt_pk_bf16_f32 v109, 0, v109
  v_cvt_pk_bf16_f32 v110, 0, v110
  v_cvt_pk_bf16_f32 v111, 0, v111
  v_mul_f32 v112, v108, v108
  v_mul_f32 v113, v109, v109
  v_mul_f32 v114, v110, v110
  v_mul_f32 v115, v111, v111
  v_fma_f32 v112, v112, v116, s78
  v_fma_f32 v113, v113, v116, s78
  v_fma_f32 v114, v114, v116, s78
  v_fma_f32 v115, v115, v116, s78
  v_mul_f32 v112, v112, v108
  v_mul_f32 v113, v113, v109
  v_mul_f32 v114, v114, v110
  v_mul_f32 v115, v115, v111
  v_exp_f32 v112, v112
  v_exp_f32 v113, v113
  v_exp_f32 v114, v114
  v_exp_f32 v115, v115
  v_add_f32 v112, 1.0, v112
  v_add_f32 v113, 1.0, v113
  v_add_f32 v114, 1.0, v114
  v_add_f32 v115, 1.0, v115
  v_rcp_f32 v112, v112
  v_rcp_f32 v113, v113
  v_rcp_f32 v114, v114
  v_rcp_f32 v115, v115
  v_mul_f32 v108, v108, v112
  v_mul_f32 v109, v109, v113
  v_mul_f32 v110, v110, v114
  v_mul_f32 v111, v111, v115
  v_cvt_pk_bf16_f32 v112, v108, v109
  v_cvt_pk_bf16_f32 v113, v110, v111
  v_dot2c_f32_bf16 v26, v112, v60
  v_dot2c_f32_bf16 v27, v113, v60
  s_waitcnt vmcnt(4)
  s_add_u32 m0, s68, 16384
  s_mov_b32 s72, 0x10000
  buffer_load_dwordx4 v8, s[32:35], s72 offen offset:0 nt lds
  buffer_load_dwordx4 v9, s[32:35], s72 offen offset:1024 nt lds
  buffer_load_dwordx4 v10, s[32:35], s72 offen offset:2048 nt lds
  buffer_load_dwordx4 v11, s[32:35], s72 offen offset:3072 nt lds
  v_lshlrev_b32 v104, 16, v53
  v_and_b32 v105, 0xffff0000, v53
  v_lshlrev_b32 v106, 16, v57
  v_and_b32 v107, 0xffff0000, v57
  s_mov_b32 s78, 0xc0135761
  v_mov_b32 v116, 0xbdd2d3e8
  v_mul_f32 v108, v64, v104
  v_mul_f32 v109, v64, v105
  v_mul_f32 v110, v65, v104
  v_mul_f32 v111, v65, v105
  v_cvt_pk_bf16_f32 v108, 0, v108
  v_cvt_pk_bf16_f32 v109, 0, v109
  v_cvt_pk_bf16_f32 v110, 0, v110
  v_cvt_pk_bf16_f32 v111, 0, v111
  v_add_f32 v108, v108, v106
  v_add_f32 v109, v109, v107
  v_add_f32 v110, v110, v106
  v_add_f32 v111, v111, v107
  v_cvt_pk_bf16_f32 v108, 0, v108
  v_cvt_pk_bf16_f32 v109, 0, v109
  v_cvt_pk_bf16_f32 v110, 0, v110
  v_cvt_pk_bf16_f32 v111, 0, v111
  v_mul_f32 v112, v108, v108
  v_mul_f32 v113, v109, v109
  v_mul_f32 v114, v110, v110
  v_mul_f32 v115, v111, v111
  v_fma_f32 v112, v112, v116, s78
  v_fma_f32 v113, v113, v116, s78
  v_fma_f32 v114, v114, v116, s78
  v_fma_f32 v115, v115, v116, s78
  v_mul_f32 v112, v112, v108
  v_mul_f32 v113, v113, v109
  v_mul_f32 v114, v114, v110
  v_mul_f32 v115, v115, v111
  v_exp_f32 v112, v112
  v_exp_f32 v113, v113
  v_exp_f32 v114, v114
  v_exp_f32 v115, v115
  v_add_f32 v112, 1.0, v112
  v_add_f32 v113, 1.0, v113
  v_add_f32 v114, 1.0, v114
  v_add_f32 v115, 1.0, v115
  v_rcp_f32 v112, v112
  v_rcp_f32 v113, v113
  v_rcp_f32 v114, v114
  v_rcp_f32 v115, v115
  v_mul_f32 v108, v108, v112
  v_mul_f32 v109, v109, v113
  v_mul_f32 v110, v110, v114
  v_mul_f32 v111, v111, v115
  v_cvt_pk_bf16_f32 v112, v108, v109
  v_cvt_pk_bf16_f32 v113, v110, v111
  v_dot2c_f32_bf16 v26, v112, v61
  v_dot2c_f32_bf16 v27, v113, v61
  s_waitcnt vmcnt(4)
  s_add_u32 m0, s68, 20480
  s_mov_b32 s72, 0x14000
  buffer_load_dwordx4 v8, s[32:35], s72 offen offset:0 nt lds
  buffer_load_dwordx4 v9, s[32:35], s72 offen offset:1024 nt lds
  buffer_load_dwordx4 v10, s[32:35], s72 offen offset:2048 nt lds
  buffer_load_dwordx4 v11, s[32:35], s72 offen offset:3072 nt lds
  v_lshlrev_b32 v104, 16, v54
  v_and_b32 v105, 0xffff0000, v54
  v_lshlrev_b32 v106, 16, v58
  v_and_b32 v107, 0xffff0000, v58
  s_mov_b32 s78, 0xc0135761
  v_mov_b32 v116, 0xbdd2d3e8
  v_mul_f32 v108, v64, v104
  v_mul_f32 v109, v64, v105
  v_mul_f32 v110, v65, v104
  v_mul_f32 v111, v65, v105
  v_cvt_pk_bf16_f32 v108, 0, v108
  v_cvt_pk_bf16_f32 v109, 0, v109
  v_cvt_pk_bf16_f32 v110, 0, v110
  v_cvt_pk_bf16_f32 v111, 0, v111
  v_add_f32 v108, v108, v106
  v_add_f32 v109, v109, v107
  v_add_f32 v110, v110, v106
  v_add_f32 v111, v111, v107
  v_cvt_pk_bf16_f32 v108, 0, v108
  v_cvt_pk_bf16_f32 v109, 0, v109
  v_cvt_pk_bf16_f32 v110, 0, v110
  v_cvt_pk_bf16_f32 v111, 0, v111
  v_mul_f32 v112, v108, v108
  v_mul_f32 v113, v109, v109
  v_mul_f32 v114, v110, v110
  v_mul_f32 v115, v111, v111
  v_fma_f32 v112, v112, v116, s78
  v_fma_f32 v113, v113, v116, s78
  v_fma_f32 v114, v114, v116, s78
  v_fma_f32 v115, v115, v116, s78
  v_mul_f32 v112, v112, v108
  v_mul_f32 v113, v113, v109
  v_mul_f32 v114, v114, v110
  v_mul_f32 v115, v115, v111
  v_exp_f32 v112, v112
  v_exp_f32 v113, v113
  v_exp_f32 v114, v114
  v_exp_f32 v115, v115
  v_add_f32 v112, 1.0, v112
  v_add_f32 v113, 1.0, v113
  v_add_f32 v114, 1.0, v114
  v_add_f32 v115, 1.0, v115
  v_rcp_f32 v112, v112
  v_rcp_f32 v113, v113
  v_rcp_f32 v114, v114
  v_rcp_f32 v115, v115
  v_mul_f32 v108, v108, v112
  v_mul_f32 v109, v109, v113
  v_mul_f32 v110, v110, v114
  v_mul_f32 v111, v111, v115
  v_cvt_pk_bf16_f32 v112, v108, v109
  v_cvt_pk_bf16_f32 v113, v110, v111
  v_dot2c_f32_bf16 v26, v112, v62
  v_dot2c_f32_bf16 v27, v113, v62
  s_waitcnt vmcnt(4)
  s_add_u32 m0, s68, 24576
  s_mov_b32 s72, 0x18000
  buffer_load_dwordx4 v8, s[32:35], s72 offen offset:0 nt lds
  buffer_load_dwordx4 v9, s[32:35], s72 offen offset:1024 nt lds
  buffer_load_dwordx4 v10, s[32:35], s72 offen offset:2048 nt lds
  buffer_load_dwordx4 v11, s[32:35], s72 offen offset:3072 nt lds
  v_lshlrev_b32 v104, 16, v55
  v_and_b32 v105, 0xffff0000, v55
  v_lshlrev_b32 v106, 16, v59
  v_and_b32 v107, 0xffff0000, v59
  s_mov_b32 s78, 0xc0135761
  v_mov_b32 v116, 0xbdd2d3e8
  v_mul_f32 v108, v64, v104
  v_mul_f32 v109, v64, v105
  v_mul_f32 v110, v65, v104
  v_mul_f32 v111, v65, v105
  v_cvt_pk_bf16_f32 v108, 0, v108
  v_cvt_pk_bf16_f32 v109, 0, v109
  v_cvt_pk_bf16_f32 v110, 0, v110
  v_cvt_pk_bf16_f32 v111, 0, v111
  v_add_f32 v108, v108, v106
  v_add_f32 v109, v109, v107
  v_add_f32 v110, v110, v106
  v_add_f32 v111, v111, v107
  v_cvt_pk_bf16_f32 v108, 0, v108
  v_cvt_pk_bf16_f32 v109, 0, v109
  v_cvt_pk_bf16_f32 v110, 0, v110
  v_cvt_pk_bf16_f32 v111, 0, v111
  v_mul_f32 v112, v108, v108
  v_mul_f32 v113, v109, v109
  v_mul_f32 v114, v110, v110
  v_mul_f32 v115, v111, v111
  v_fma_f32 v112, v112, v116, s78
  v_fma_f32 v113, v113, v116, s78
  v_fma_f32 v114, v114, v116, s78
  v_fma_f32 v115, v115, v116, s78
  v_mul_f32 v112, v112, v108
  v_mul_f32 v113, v113, v109
  v_mul_f32 v114, v114, v110
  v_mul_f32 v115, v115, v111
  v_exp_f32 v112, v112
  v_exp_f32 v113, v113
  v_exp_f32 v114, v114
  v_exp_f32 v115, v115
  v_add_f32 v112, 1.0, v112
  v_add_f32 v113, 1.0, v113
  v_add_f32 v114, 1.0, v114
  v_add_f32 v115, 1.0, v115
  v_rcp_f32 v112, v112
  v_rcp_f32 v113, v113
  v_rcp_f32 v114, v114
  v_rcp_f32 v115, v115
  v_mul_f32 v108, v108, v112
  v_mul_f32 v109, v109, v113
  v_mul_f32 v110, v110, v114
  v_mul_f32 v111, v111, v115
  v_cvt_pk_bf16_f32 v112, v108, v109
  v_cvt_pk_bf16_f32 v113, v110, v111
  v_dot2c_f32_bf16 v26, v112, v63
  v_dot2c_f32_bf16 v27, v113, v63
  s_waitcnt vmcnt(4)
  s_add_u32 m0, s68, 28672
  s_mov_b32 s72, 0x1c000
  buffer_load_dwordx4 v8, s[32:35], s72 offen offset:0 nt lds
  buffer_load_dwordx4 v9, s[32:35], s72 offen offset:1024 nt lds
  buffer_load_dwordx4 v10, s[32:35], s72 offen offset:2048 nt lds
  buffer_load_dwordx4 v11, s[32:35], s72 offen offset:3072 nt lds
  v_add_f32_dpp v26, v26, v26 row_ror:1 row_mask:0xf bank_mask:0xf
  v_add_f32_dpp v27, v27, v27 row_ror:1 row_mask:0xf bank_mask:0xf
  s_nop 0
  v_add_f32_dpp v26, v26, v26 row_ror:2 row_mask:0xf bank_mask:0xf
  v_add_f32_dpp v27, v27, v27 row_ror:2 row_mask:0xf bank_mask:0xf
  s_nop 0
  v_add_f32_dpp v26, v26, v26 row_ror:4 row_mask:0xf bank_mask:0xf
  v_add_f32_dpp v27, v27, v27 row_ror:4 row_mask:0xf bank_mask:0xf
  s_nop 0
  v_add_f32_dpp v26, v26, v26 row_ror:8 row_mask:0xf bank_mask:0xf
  v_add_f32_dpp v27, v27, v27 row_ror:8 row_mask:0xf bank_mask:0xf
  v_mov_b32 v104, v26
  v_mov_b32 v105, v27
  s_nop 0
  v_permlane16_swap_b32 v26, v104
  v_permlane16_swap_b32 v27, v105
  v_add_f32 v26, v26, v104
  v_add_f32 v27, v27, v105
  v_mov_b32 v104, v26
  v_mov_b32 v105, v27
  s_nop 0
  v_permlane32_swap_b32 v26, v104
  v_permlane32_swap_b32 v27, v105
  v_add_f32 v26, v26, v104
  v_add_f32 v27, v27, v105
  s_lshl_b32 s70, s3, 3
  s_add_u32 s70, s70, 149632
  v_mov_b32 v104, s70
  s_mov_b64 exec, 1
  ds_write_b64 v104, v[26:27]
  s_mov_b64 exec, -1
  s_waitcnt vmcnt(4)
  s_mov_b32 s72, 0x0
  buffer_load_dwordx4 a[0:3], v16, s[36:39], s72 offen offset:0 nt
  buffer_load_dwordx4 a[4:7], v16, s[36:39], s72 offen offset:256 nt
  buffer_load_dwordx4 a[8:11], v16, s[36:39], s72 offen offset:512 nt
  buffer_load_dwordx4 a[12:15], v16, s[36:39], s72 offen offset:768 nt
  s_waitcnt vmcnt(4)
  s_mov_b32 s72, 0x4000
  buffer_load_dwordx4 a[16:19], v16, s[36:39], s72 offen offset:0 nt
  buffer_load_dwordx4 a[20:23], v16, s[36:39], s72 offen offset:256 nt
  buffer_load_dwordx4 a[24:27], v16, s[36:39], s72 offen offset:512 nt
  buffer_load_dwordx4 a[28:31], v16, s[36:39], s72 offen offset:768 nt
  v_and_b32 v138, 31, v0
  v_lshlrev_b32 v138, 3, v138
  buffer_load_dwordx4 v[88:91], v3, s[48:51], s74 offen
  s_add_u32 s72, s74, 4096
  buffer_load_dwordx4 v[92:95], v3, s[48:51], s72 offen
  s_add_u32 s72, s74, 8192
  buffer_load_dwordx4 v[96:99], v3, s[48:51], s72 offen
  s_add_u32 s72, s74, 12288
  buffer_load_dwordx4 v[100:103], v3, s[48:51], s72 offen
  s_lshl_b32 s72, s64, 8
  s_add_u32 s72, s72, 0x8000
  buffer_load_dwordx2 v[136:137], v138, s[48:51], s72 offen
  s_waitcnt vmcnt(9)
  s_mov_b32 s72, 0x8000
  buffer_load_dwordx4 a[32:35], v16, s[36:39], s72 offen offset:0 nt
  buffer_load_dwordx4 a[36:39], v16, s[36:39], s72 offen offset:256 nt
  buffer_load_dwordx4 a[40:43], v16, s[36:39], s72 offen offset:512 nt
  buffer_load_dwordx4 a[44:47], v16, s[36:39], s72 offen offset:768 nt
  s_waitcnt vmcnt(9)
  s_mov_b32 s72, 0xc000
  buffer_load_dwordx4 a[48:51], v16, s[36:39], s72 offen offset:0 nt
  buffer_load_dwordx4 a[52:55], v16, s[36:39], s72 offen offset:256 nt
  buffer_load_dwordx4 a[56:59], v16, s[36:39], s72 offen offset:512 nt
  buffer_load_dwordx4 a[60:63], v16, s[36:39], s72 offen offset:768 nt
  s_waitcnt vmcnt(8)
  v_bitop3_b32 v104, v88, v89, v90 bitop3:0x96
  v_bitop3_b32 v105, v92, v93, v94 bitop3:0x96
  v_bitop3_b32 v106, v96, v97, v98 bitop3:0x96
  v_bitop3_b32 v107, v100, v101, v102 bitop3:0x96
  v_bitop3_b32 v104, v104, v91, v2 bitop3:0x96
  v_bitop3_b32 v105, v105, v95, v2 bitop3:0x96
  v_bitop3_b32 v106, v106, v99, v2 bitop3:0x96
  v_bitop3_b32 v107, v107, v103, v2 bitop3:0x96
  v_or3_b32 v32, v104, v105, v106
  v_bitop3_b32 v104, v136, v137, v2 bitop3:0x96
  v_or3_b32 v32, v32, v107, v104
  v_cmp_ne_u32 vcc, 0, v32
  s_cbranch_vccnz L_qretry
L_qok:
  v_add_f32 v88, v88, v92
  v_add_f32 v96, v96, v100
  v_add_f32 v89, v89, v93
  v_add_f32 v97, v97, v101
  v_add_f32 v88, v88, v96
  v_add_f32 v89, v89, v97
  v_cvt_pk_bf16_f32 v88, v88, v89
  v_lshlrev_b32 v89, 2, v0
  v_add_u32 v89, 148480, v89
  ds_write_b32 v89, v88
  v_cmp_ne_u32 vcc, s30, v136
  s_lshl_b32 s70, s3, 2
  s_add_u32 s70, s70, 149664
  s_or_b32 s71, vcc_lo, vcc_hi
  v_mov_b32 v104, s70
  v_mov_b32 v105, s71
  ds_write_b32 v104, v105
  s_waitcnt vmcnt(4)
  s_mov_b32 s72, 0x10000
  buffer_load_dwordx4 a[64:67], v16, s[36:39], s72 offen offset:0 nt
  buffer_load_dwordx4 a[68:71], v16, s[36:39], s72 offen offset:256 nt
  buffer_load_dwordx4 a[72:75], v16, s[36:39], s72 offen offset:512 nt
  buffer_load_dwordx4 a[76:79], v16, s[36:39], s72 offen offset:768 nt
  v_mov_b32 v32, 149664
  s_waitcnt lgkmcnt(0)
  s_barrier
  ds_read_b128 v[36:39], v32
  ds_read_b128 v[72:75], v220 offset:0
  ds_read_b128 v[76:79], v220 offset:64
  ds_read_b128 v[80:83], v220 offset:128
  ds_read_b128 v[84:87], v220 offset:192
  ds_read_b128 v[104:107], v12 offset:0
  ds_read_b128 v[108:111], v13 offset:0
  ds_read_b128 v[112:115], v14 offset:0
  ds_read_b128 v[116:119], v15 offset:0
  ds_read_b128 v[120:123], v12 offset:4096
  ds_read_b128 v[124:127], v13 offset:4096
  ds_read_b128 v[128:131], v14 offset:4096
  ds_read_b128 v[132:135], v15 offset:4096
  s_waitcnt lgkmcnt(7)
  v_mfma_f32_16x16x32_bf16 v[200:203], v[104:107], v[72:75], 0
  s_waitcnt lgkmcnt(6)
  v_mfma_f32_16x16x32_bf16 v[200:203], v[108:111], v[76:79], v[200:203]
  s_waitcnt lgkmcnt(5)
  v_mfma_f32_16x16x32_bf16 v[200:203], v[112:115], v[80:83], v[200:203]
  s_waitcnt lgkmcnt(4)
  v_mfma_f32_16x16x32_bf16 v[200:203], v[116:119], v[84:87], v[200:203]
  s_waitcnt lgkmcnt(3)
  v_mfma_f32_16x16x32_bf16 v[204:207], v[120:123], v[72:75], 0
  s_waitcnt lgkmcnt(2)
  v_mfma_f32_16x16x32_bf16 v[204:207], v[124:127], v[76:79], v[204:207]
  s_waitcnt lgkmcnt(1)
  v_mfma_f32_16x16x32_bf16 v[204:207], v[128:131], v[80:83], v[204:207]
  s_waitcnt lgkmcnt(0)
  v_mfma_f32_16x16x32_bf16 v[204:207], v[132:135], v[84:87], v[204:207]
  s_mov_b32 s78, 0x3db504f3
  v_cvt_pk_bf16_f32 v136, 0, v200
  v_cvt_pk_bf16_f32 v137, 0, v201
  v_cvt_pk_bf16_f32 v138, 0, v202
  v_cvt_pk_bf16_f32 v139, 0, v203
  s_nop 2
  v_cvt_pk_bf16_f32 v140, 0, v204
  v_cvt_pk_bf16_f32 v141, 0, v205
  v_cvt_pk_bf16_f32 v142, 0, v206
  v_cvt_pk_bf16_f32 v143, 0, v207
  v_mul_f32 v136, s78, v136
  v_mul_f32 v137, s78, v137
  v_mul_f32 v138, s78, v138
  v_mul_f32 v139, s78, v139
  v_mul_f32 v140, s78, v140
  v_mul_f32 v141, s78, v141
  v_mul_f32 v142, s78, v142
  v_mul_f32 v143, s78, v143
  v_cvt_pk_bf16_f32 v136, 0, v136
  v_cvt_pk_bf16_f32 v137, 0, v137
  v_cvt_pk_bf16_f32 v138, 0, v138
  v_cvt_pk_bf16_f32 v139, 0, v139
  v_cvt_pk_bf16_f32 v140, 0, v140
  v_cvt_pk_bf16_f32 v141, 0, v141
  v_cvt_pk_bf16_f32 v142, 0, v142
  v_cvt_pk_bf16_f32 v143, 0, v143
  v_max3_f32 v24, v136, v137, v138
  v_max3_f32 v24, v24, v139, v140
  v_max3_f32 v24, v24, v141, v142
  v_max_f32 v24, v24, v143
  s_waitcnt vmcnt(4)
  s_mov_b32 s72, 0x14000
  buffer_load_dwordx4 a[80:83], v16, s[36:39], s72 offen offset:0 nt
  buffer_load_dwordx4 a[84:87], v16, s[36:39], s72 offen offset:256 nt
  buffer_load_dwordx4 a[88:91], v16, s[36:39], s72 offen offset:512 nt
  buffer_load_dwordx4 a[92:95], v16, s[36:39], s72 offen offset:768 nt
  ds_read_b128 v[104:107], v12 offset:8192
  ds_read_b128 v[108:111], v13 offset:8192
  ds_read_b128 v[112:115], v14 offset:8192
  ds_read_b128 v[116:119], v15 offset:8192
  ds_read_b128 v[120:123], v12 offset:12288
  ds_read_b128 v[124:127], v13 offset:12288
  ds_read_b128 v[128:131], v14 offset:12288
  ds_read_b128 v[132:135], v15 offset:12288
  s_waitcnt lgkmcnt(7)
  v_mfma_f32_16x16x32_bf16 v[200:203], v[104:107], v[72:75], 0
  s_waitcnt lgkmcnt(6)
  v_mfma_f32_16x16x32_bf16 v[200:203], v[108:111], v[76:79], v[200:203]
  s_waitcnt lgkmcnt(5)
  v_mfma_f32_16x16x32_bf16 v[200:203], v[112:115], v[80:83], v[200:203]
  s_waitcnt lgkmcnt(4)
  v_mfma_f32_16x16x32_bf16 v[200:203], v[116:119], v[84:87], v[200:203]
  s_waitcnt lgkmcnt(3)
  v_mfma_f32_16x16x32_bf16 v[204:207], v[120:123], v[72:75], 0
  s_waitcnt lgkmcnt(2)
  v_mfma_f32_16x16x32_bf16 v[204:207], v[124:127], v[76:79], v[204:207]
  s_waitcnt lgkmcnt(1)
  v_mfma_f32_16x16x32_bf16 v[204:207], v[128:131], v[80:83], v[204:207]
  s_waitcnt lgkmcnt(0)
  v_mfma_f32_16x16x32_bf16 v[204:207], v[132:135], v[84:87], v[204:207]
  s_mov_b32 s78, 0x3db504f3
  v_cvt_pk_bf16_f32 v144, 0, v200
  v_cvt_pk_bf16_f32 v145, 0, v201
  v_cvt_pk_bf16_f32 v146, 0, v202
  v_cvt_pk_bf16_f32 v147, 0, v203
  s_nop 2
  v_cvt_pk_bf16_f32 v148, 0, v204
  v_cvt_pk_bf16_f32 v149, 0, v205
  v_cvt_pk_bf16_f32 v150, 0, v206
  v_cvt_pk_bf16_f32 v151, 0, v207
  v_mul_f32 v144, s78, v144
  v_mul_f32 v145, s78, v145
  v_mul_f32 v146, s78, v146
  v_mul_f32 v147, s78, v147
  v_mul_f32 v148, s78, v148
  v_mul_f32 v149, s78, v149
  v_mul_f32 v150, s78, v150
  v_mul_f32 v151, s78, v151
  v_cvt_pk_bf16_f32 v144, 0, v144
  v_cvt_pk_bf16_f32 v145, 0, v145
  v_cvt_pk_bf16_f32 v146, 0, v146
  v_cvt_pk_bf16_f32 v147, 0, v147
  v_cvt_pk_bf16_f32 v148, 0, v148
  v_cvt_pk_bf16_f32 v149, 0, v149
  v_cvt_pk_bf16_f32 v150, 0, v150
  v_cvt_pk_bf16_f32 v151, 0, v151
  v_max3_f32 v24, v24, v144, v145
  v_max3_f32 v24, v24, v146, v147
  v_max3_f32 v24, v24, v148, v149
  v_max3_f32 v24, v24, v150, v151
  s_waitcnt vmcnt(4)
  s_mov_b32 s72, 0x18000
  buffer_load_dwordx4 a[96:99], v16, s[36:39], s72 offen offset:0 nt
  buffer_load_dwordx4 a[100:103], v16, s[36:39], s72 offen offset:256 nt
  buffer_load_dwordx4 a[104:107], v16, s[36:39], s72 offen offset:512 nt
  buffer_load_dwordx4 a[108:111], v16, s[36:39], s72 offen offset:768 nt
  ds_read_b128 v[104:107], v12 offset:16384
  ds_read_b128 v[108:111], v13 offset:16384
  ds_read_b128 v[112:115], v14 offset:16384
  ds_read_b128 v[116:119], v15 offset:16384
  ds_read_b128 v[120:123], v12 offset:20480
  ds_read_b128 v[124:127], v13 offset:20480
  ds_read_b128 v[128:131], v14 offset:20480
  ds_read_b128 v[132:135], v15 offset:20480
  s_waitcnt lgkmcnt(7)
  v_mfma_f32_16x16x32_bf16 v[200:203], v[104:107], v[72:75], 0
  s_waitcnt lgkmcnt(6)
  v_mfma_f32_16x16x32_bf16 v[200:203], v[108:111], v[76:79], v[200:203]
  s_waitcnt lgkmcnt(5)
  v_mfma_f32_16x16x32_bf16 v[200:203], v[112:115], v[80:83], v[200:203]
  s_waitcnt lgkmcnt(4)
  v_mfma_f32_16x16x32_bf16 v[200:203], v[116:119], v[84:87], v[200:203]
  s_waitcnt lgkmcnt(3)
  v_mfma_f32_16x16x32_bf16 v[204:207], v[120:123], v[72:75], 0
  s_waitcnt lgkmcnt(2)
  v_mfma_f32_16x16x32_bf16 v[204:207], v[124:127], v[76:79], v[204:207]
  s_waitcnt lgkmcnt(1)
  v_mfma_f32_16x16x32_bf16 v[204:207], v[128:131], v[80:83], v[204:207]
  s_waitcnt lgkmcnt(0)
  v_mfma_f32_16x16x32_bf16 v[204:207], v[132:135], v[84:87], v[204:207]
  s_mov_b32 s78, 0x3db504f3
  v_cvt_pk_bf16_f32 v152, 0, v200
  v_cvt_pk_bf16_f32 v153, 0, v201
  v_cvt_pk_bf16_f32 v154, 0, v202
  v_cvt_pk_bf16_f32 v155, 0, v203
  s_nop 2
  v_cvt_pk_bf16_f32 v156, 0, v204
  v_cvt_pk_bf16_f32 v157, 0, v205
  v_cvt_pk_bf16_f32 v158, 0, v206
  v_cvt_pk_bf16_f32 v159, 0, v207
  v_mul_f32 v152, s78, v152
  v_mul_f32 v153, s78, v153
  v_mul_f32 v154, s78, v154
  v_mul_f32 v155, s78, v155
  v_mul_f32 v156, s78, v156
  v_mul_f32 v157, s78, v157
  v_mul_f32 v158, s78, v158
  v_mul_f32 v159, s78, v159
  v_cvt_pk_bf16_f32 v152, 0, v152
  v_cvt_pk_bf16_f32 v153, 0, v153
  v_cvt_pk_bf16_f32 v154, 0, v154
  v_cvt_pk_bf16_f32 v155, 0, v155
  v_cvt_pk_bf16_f32 v156, 0, v156
  v_cvt_pk_bf16_f32 v157, 0, v157
  v_cvt_pk_bf16_f32 v158, 0, v158
  v_cvt_pk_bf16_f32 v159, 0, v159
  v_max3_f32 v24, v24, v152, v153
  v_max3_f32 v24, v24, v154, v155
  v_max3_f32 v24, v24, v156, v157
  v_max3_f32 v24, v24, v158, v159
  s_waitcnt vmcnt(4)
  s_mov_b32 s72, 0x1c000
  buffer_load_dwordx4 a[112:115], v16, s[36:39], s72 offen offset:0 nt
  buffer_load_dwordx4 a[116:119], v16, s[36:39], s72 offen offset:256 nt
  buffer_load_dwordx4 a[120:123], v16, s[36:39], s72 offen offset:512 nt
  buffer_load_dwordx4 a[124:127], v16, s[36:39], s72 offen offset:768 nt
  ds_read_b128 v[104:107], v12 offset:24576
  ds_read_b128 v[108:111], v13 offset:24576
  ds_read_b128 v[112:115], v14 offset:24576
  ds_read_b128 v[116:119], v15 offset:24576
  ds_read_b128 v[120:123], v12 offset:28672
  ds_read_b128 v[124:127], v13 offset:28672
  ds_read_b128 v[128:131], v14 offset:28672
  ds_read_b128 v[132:135], v15 offset:28672
  s_waitcnt lgkmcnt(7)
  v_mfma_f32_16x16x32_bf16 v[200:203], v[104:107], v[72:75], 0
  s_waitcnt lgkmcnt(6)
  v_mfma_f32_16x16x32_bf16 v[200:203], v[108:111], v[76:79], v[200:203]
  s_waitcnt lgkmcnt(5)
  v_mfma_f32_16x16x32_bf16 v[200:203], v[112:115], v[80:83], v[200:203]
  s_waitcnt lgkmcnt(4)
  v_mfma_f32_16x16x32_bf16 v[200:203], v[116:119], v[84:87], v[200:203]
  s_waitcnt lgkmcnt(3)
  v_mfma_f32_16x16x32_bf16 v[204:207], v[120:123], v[72:75], 0
  s_waitcnt lgkmcnt(2)
  v_mfma_f32_16x16x32_bf16 v[204:207], v[124:127], v[76:79], v[204:207]
  s_waitcnt lgkmcnt(1)
  v_mfma_f32_16x16x32_bf16 v[204:207], v[128:131], v[80:83], v[204:207]
  s_waitcnt lgkmcnt(0)
  v_mfma_f32_16x16x32_bf16 v[204:207], v[132:135], v[84:87], v[204:207]
  s_mov_b32 s78, 0x3db504f3
  v_cvt_pk_bf16_f32 v160, 0, v200
  v_cvt_pk_bf16_f32 v161, 0, v201
  v_cvt_pk_bf16_f32 v162, 0, v202
  v_cvt_pk_bf16_f32 v163, 0, v203
  s_nop 2
  v_cvt_pk_bf16_f32 v164, 0, v204
  v_cvt_pk_bf16_f32 v165, 0, v205
  v_cvt_pk_bf16_f32 v166, 0, v206
  v_cvt_pk_bf16_f32 v167, 0, v207
  v_mul_f32 v160, s78, v160
  v_mul_f32 v161, s78, v161
  v_mul_f32 v162, s78, v162
  v_mul_f32 v163, s78, v163
  v_mul_f32 v164, s78, v164
  v_mul_f32 v165, s78, v165
  v_mul_f32 v166, s78, v166
  v_mul_f32 v167, s78, v167
  v_cvt_pk_bf16_f32 v160, 0, v160
  v_cvt_pk_bf16_f32 v161, 0, v161
  v_cvt_pk_bf16_f32 v162, 0, v162
  v_cvt_pk_bf16_f32 v163, 0, v163
  v_cvt_pk_bf16_f32 v164, 0, v164
  v_cvt_pk_bf16_f32 v165, 0, v165
  v_cvt_pk_bf16_f32 v166, 0, v166
  v_cvt_pk_bf16_f32 v167, 0, v167
  v_max3_f32 v24, v24, v160, v161
  v_max3_f32 v24, v24, v162, v163
  v_max3_f32 v24, v24, v164, v165
  v_max3_f32 v24, v24, v166, v167
  v_or3_b32 v36, v36, v37, v38
  v_or_b32 v36, v36, v39
  s_nop 0
  v_readfirstlane_b32 s31, v36
  v_and_b32 v32, 31, v0
  v_lshlrev_b32 v32, 7, v32
  v_add_u32 v32, L_tail-L_pc, v32
  v_min_u32 v32, L_codeend-L_pc-4, v32
  global_load_dword v30, v32, s[76:77]
  s_mul_i32 s70, s3, 2304
  s_add_u32 s70, s70, 131072
  v_lshlrev_b32 v56, 4, v1
  v_add_u32 v56, s70, v56
  v_lshlrev_b32 v57, 3, v0
  v_add_u32 v60, 140288, v57
  v_and_b32 v57, 8, v57
  v_lshrrev_b32 v58, 2, v0
  v_lshl_add_u32 v57, v58, 4, v57
  v_bfe_u32 v58, v0, 1, 1
  v_mul_u32_u24 v58, 1152, v58
  v_add_u32 v57, v58, v57
  v_add_u32 v57, 131072, v57
  v_lshrrev_b32 v58, 3, v1
  v_mul_u32_u24 v58, 4096, v58
  v_and_b32 v59, 7, v1
  v_lshl_add_u32 v58, v59, 4, v58
  v_mul_u32_u24 v59, 1152, v1
  s_mul_i32 s75, s67, 4096
  s_add_u32 s75, s75, 0x100000
  s_and_b32 s70, s67, 0xe0
  s_mul_i32 s70, s70, 4096
  s_and_b32 s71, s67, 0x1c
  s_add_u32 s71, s71, s3
  s_lshl_b32 s71, s71, 7
  s_add_u32 s70, s70, s71
  s_add_u32 s52, s70, 0x100000
  s_add_u32 s53, s70, 0x108000
  s_add_u32 s54, s70, 0x110000
  s_add_u32 s55, s70, 0x118000
  s_and_b32 s70, s67, 3
  s_lshl_b32 s70, s70, 6
  s_lshr_b32 s71, s67, 2
  s_add_u32 s70, s70, s71
  s_mul_i32 s70, s70, 1152
  s_add_u32 s56, s70, 0x40000
  s_and_b32 s70, s66, 0xc0
  s_mul_i32 s70, s70, 1152
  s_and_b32 s71, s66, 63
  s_lshl_b32 s71, s71, 4
  s_add_u32 s70, s70, s71
  s_add_u32 s57, s70, 0x40000
  s_waitcnt vmcnt(5)
  s_add_u32 m0, s68, 0
  s_mov_b32 s72, 0x20000
  buffer_load_dwordx4 v8, s[32:35], s72 offen offset:0 nt lds
  buffer_load_dwordx4 v9, s[32:35], s72 offen offset:1024 nt lds
  buffer_load_dwordx4 v10, s[32:35], s72 offen offset:2048 nt lds
  buffer_load_dwordx4 v11, s[32:35], s72 offen offset:3072 nt lds
  s_waitcnt vmcnt(5)
  s_add_u32 m0, s68, 4096
  s_mov_b32 s72, 0x24000
  buffer_load_dwordx4 v8, s[32:35], s72 offen offset:0 nt lds
  buffer_load_dwordx4 v9, s[32:35], s72 offen offset:1024 nt lds
  buffer_load_dwordx4 v10, s[32:35], s72 offen offset:2048 nt lds
  buffer_load_dwordx4 v11, s[32:35], s72 offen offset:3072 nt lds
  s_waitcnt vmcnt(4)
  s_add_u32 m0, s68, 8192
  s_mov_b32 s72, 0x28000
  buffer_load_dwordx4 v8, s[32:35], s72 offen offset:0 nt lds
  buffer_load_dwordx4 v9, s[32:35], s72 offen offset:1024 nt lds
  buffer_load_dwordx4 v10, s[32:35], s72 offen offset:2048 nt lds
  buffer_load_dwordx4 v11, s[32:35], s72 offen offset:3072 nt lds
  s_waitcnt vmcnt(4)
  s_add_u32 m0, s68, 12288
  s_mov_b32 s72, 0x2c000
  buffer_load_dwordx4 v8, s[32:35], s72 offen offset:0 nt lds
  buffer_load_dwordx4 v9, s[32:35], s72 offen offset:1024 nt lds
  buffer_load_dwordx4 v10, s[32:35], s72 offen offset:2048 nt lds
  buffer_load_dwordx4 v11, s[32:35], s72 offen offset:3072 nt lds
  ds_read_b128 v[104:107], v12 offset:0
  ds_read_b128 v[108:111], v13 offset:0
  ds_read_b128 v[112:115], v14 offset:0
  ds_read_b128 v[116:119], v15 offset:0
  ds_read_b128 v[120:123], v12 offset:4096
  ds_read_b128 v[124:127], v13 offset:4096
  ds_read_b128 v[128:131], v14 offset:4096
  ds_read_b128 v[132:135], v15 offset:4096
  s_waitcnt lgkmcnt(7)
  v_mfma_f32_16x16x32_bf16 v[200:203], v[104:107], v[72:75], 0
  s_waitcnt lgkmcnt(6)
  v_mfma_f32_16x16x32_bf16 v[200:203], v[108:111], v[76:79], v[200:203]
  s_waitcnt lgkmcnt(5)
  v_mfma_f32_16x16x32_bf16 v[200:203], v[112:115], v[80:83], v[200:203]
  s_waitcnt lgkmcnt(4)
  v_mfma_f32_16x16x32_bf16 v[200:203], v[116:119], v[84:87], v[200:203]
  s_waitcnt lgkmcnt(3)
  v_mfma_f32_16x16x32_bf16 v[204:207], v[120:123], v[72:75], 0
  s_waitcnt lgkmcnt(2)
  v_mfma_f32_16x16x32_bf16 v[204:207], v[124:127], v[76:79], v[204:207]
  s_waitcnt lgkmcnt(1)
  v_mfma_f32_16x16x32_bf16 v[204:207], v[128:131], v[80:83], v[204:207]
  s_waitcnt lgkmcnt(0)
  v_mfma_f32_16x16x32_bf16 v[204:207], v[132:135], v[84:87], v[204:207]
  s_mov_b32 s78, 0x3db504f3
  v_cvt_pk_bf16_f32 v168, 0, v200
  v_cvt_pk_bf16_f32 v169, 0, v201
  v_cvt_pk_bf16_f32 v170, 0, v202
  v_cvt_pk_bf16_f32 v171, 0, v203
  s_nop 2
  v_cvt_pk_bf16_f32 v172, 0, v204
  v_cvt_pk_bf16_f32 v173, 0, v205
  v_cvt_pk_bf16_f32 v174, 0, v206
  v_cvt_pk_bf16_f32 v175, 0, v207
  v_mul_f32 v168, s78, v168
  v_mul_f32 v169, s78, v169
  v_mul_f32 v170, s78, v170
  v_mul_f32 v171, s78, v171
  v_mul_f32 v172, s78, v172
  v_mul_f32 v173, s78, v173
  v_mul_f32 v174, s78, v174
  v_mul_f32 v175, s78, v175
  v_cvt_pk_bf16_f32 v168, 0, v168
  v_cvt_pk_bf16_f32 v169, 0, v169
  v_cvt_pk_bf16_f32 v170, 0, v170
  v_cvt_pk_bf16_f32 v171, 0, v171
  v_cvt_pk_bf16_f32 v172, 0, v172
  v_cvt_pk_bf16_f32 v173, 0, v173
  v_cvt_pk_bf16_f32 v174, 0, v174
  v_cvt_pk_bf16_f32 v175, 0, v175
  v_max3_f32 v24, v24, v168, v169
  v_max3_f32 v24, v24, v170, v171
  v_max3_f32 v24, v24, v172, v173
  v_max3_f32 v24, v24, v174, v175
  s_waitcnt vmcnt(4)
  s_add_u32 m0, s68, 16384
  s_mov_b32 s72, 0x30000
  buffer_load_dwordx4 v8, s[32:35], s72 offen offset:0 nt lds
  buffer_load_dwordx4 v9, s[32:35], s72 offen offset:1024 nt lds
  buffer_load_dwordx4 v10, s[32:35], s72 offen offset:2048 nt lds
  buffer_load_dwordx4 v11, s[32:35], s72 offen offset:3072 nt lds
  s_waitcnt vmcnt(4)
  s_add_u32 m0, s68, 20480
  s_mov_b32 s72, 0x34000
  buffer_load_dwordx4 v8, s[32:35], s72 offen offset:0 nt lds
  buffer_load_dwordx4 v9, s[32:35], s72 offen offset:1024 nt lds
  buffer_load_dwordx4 v10, s[32:35], s72 offen offset:2048 nt lds
  buffer_load_dwordx4 v11, s[32:35], s72 offen offset:3072 nt lds
  ds_read_b128 v[104:107], v12 offset:8192
  ds_read_b128 v[108:111], v13 offset:8192
  ds_read_b128 v[112:115], v14 offset:8192
  ds_read_b128 v[116:119], v15 offset:8192
  ds_read_b128 v[120:123], v12 offset:12288
  ds_read_b128 v[124:127], v13 offset:12288
  ds_read_b128 v[128:131], v14 offset:12288
  ds_read_b128 v[132:135], v15 offset:12288
  s_waitcnt lgkmcnt(7)
  v_mfma_f32_16x16x32_bf16 v[200:203], v[104:107], v[72:75], 0
  s_waitcnt lgkmcnt(6)
  v_mfma_f32_16x16x32_bf16 v[200:203], v[108:111], v[76:79], v[200:203]
  s_waitcnt lgkmcnt(5)
  v_mfma_f32_16x16x32_bf16 v[200:203], v[112:115], v[80:83], v[200:203]
  s_waitcnt lgkmcnt(4)
  v_mfma_f32_16x16x32_bf16 v[200:203], v[116:119], v[84:87], v[200:203]
  s_waitcnt lgkmcnt(3)
  v_mfma_f32_16x16x32_bf16 v[204:207], v[120:123], v[72:75], 0
  s_waitcnt lgkmcnt(2)
  v_mfma_f32_16x16x32_bf16 v[204:207], v[124:127], v[76:79], v[204:207]
  s_waitcnt lgkmcnt(1)
  v_mfma_f32_16x16x32_bf16 v[204:207], v[128:131], v[80:83], v[204:207]
  s_waitcnt lgkmcnt(0)
  v_mfma_f32_16x16x32_bf16 v[204:207], v[132:135], v[84:87], v[204:207]
  s_mov_b32 s78, 0x3db504f3
  v_cvt_pk_bf16_f32 v176, 0, v200
  v_cvt_pk_bf16_f32 v177, 0, v201
  v_cvt_pk_bf16_f32 v178, 0, v202
  v_cvt_pk_bf16_f32 v179, 0, v203
  s_nop 2
  v_cvt_pk_bf16_f32 v180, 0, v204
  v_cvt_pk_bf16_f32 v181, 0, v205
  v_cvt_pk_bf16_f32 v182, 0, v206
  v_cvt_pk_bf16_f32 v183, 0, v207
  v_mul_f32 v176, s78, v176
  v_mul_f32 v177, s78, v177
  v_mul_f32 v178, s78, v178
  v_mul_f32 v179, s78, v179
  v_mul_f32 v180, s78, v180
  v_mul_f32 v181, s78, v181
  v_mul_f32 v182, s78, v182
  v_mul_f32 v183, s78, v183
  v_cvt_pk_bf16_f32 v176, 0, v176
  v_cvt_pk_bf16_f32 v177, 0, v177
  v_cvt_pk_bf16_f32 v178, 0, v178
  v_cvt_pk_bf16_f32 v179, 0, v179
  v_cvt_pk_bf16_f32 v180, 0, v180
  v_cvt_pk_bf16_f32 v181, 0, v181
  v_cvt_pk_bf16_f32 v182, 0, v182
  v_cvt_pk_bf16_f32 v183, 0, v183
  v_max3_f32 v24, v24, v176, v177
  v_max3_f32 v24, v24, v178, v179
  v_max3_f32 v24, v24, v180, v181
  v_max3_f32 v24, v24, v182, v183
  s_waitcnt vmcnt(4)
  s_add_u32 m0, s68, 24576
  s_mov_b32 s72, 0x38000
  buffer_load_dwordx4 v8, s[32:35], s72 offen offset:0 nt lds
  buffer_load_dwordx4 v9, s[32:35], s72 offen offset:1024 nt lds
  buffer_load_dwordx4 v10, s[32:35], s72 offen offset:2048 nt lds
  buffer_load_dwordx4 v11, s[32:35], s72 offen offset:3072 nt lds
  s_waitcnt vmcnt(4)
  s_add_u32 m0, s68, 28672
  s_mov_b32 s72, 0x3c000
  buffer_load_dwordx4 v8, s[32:35], s72 offen offset:0 nt lds
  buffer_load_dwordx4 v9, s[32:35], s72 offen offset:1024 nt lds
  buffer_load_dwordx4 v10, s[32:35], s72 offen offset:2048 nt lds
  buffer_load_dwordx4 v11, s[32:35], s72 offen offset:3072 nt lds
  ds_read_b128 v[104:107], v12 offset:16384
  ds_read_b128 v[108:111], v13 offset:16384
  ds_read_b128 v[112:115], v14 offset:16384
  ds_read_b128 v[116:119], v15 offset:16384
  ds_read_b128 v[120:123], v12 offset:20480
  ds_read_b128 v[124:127], v13 offset:20480
  ds_read_b128 v[128:131], v14 offset:20480
  ds_read_b128 v[132:135], v15 offset:20480
  s_waitcnt lgkmcnt(7)
  v_mfma_f32_16x16x32_bf16 v[200:203], v[104:107], v[72:75], 0
  s_waitcnt lgkmcnt(6)
  v_mfma_f32_16x16x32_bf16 v[200:203], v[108:111], v[76:79], v[200:203]
  s_waitcnt lgkmcnt(5)
  v_mfma_f32_16x16x32_bf16 v[200:203], v[112:115], v[80:83], v[200:203]
  s_waitcnt lgkmcnt(4)
  v_mfma_f32_16x16x32_bf16 v[200:203], v[116:119], v[84:87], v[200:203]
  s_waitcnt lgkmcnt(3)
  v_mfma_f32_16x16x32_bf16 v[204:207], v[120:123], v[72:75], 0
  s_waitcnt lgkmcnt(2)
  v_mfma_f32_16x16x32_bf16 v[204:207], v[124:127], v[76:79], v[204:207]
  s_waitcnt lgkmcnt(1)
  v_mfma_f32_16x16x32_bf16 v[204:207], v[128:131], v[80:83], v[204:207]
  s_waitcnt lgkmcnt(0)
  v_mfma_f32_16x16x32_bf16 v[204:207], v[132:135], v[84:87], v[204:207]
  s_mov_b32 s78, 0x3db504f3
  v_cvt_pk_bf16_f32 v184, 0, v200
  v_cvt_pk_bf16_f32 v185, 0, v201
  v_cvt_pk_bf16_f32 v186, 0, v202
  v_cvt_pk_bf16_f32 v187, 0, v203
  s_nop 2
  v_cvt_pk_bf16_f32 v188, 0, v204
  v_cvt_pk_bf16_f32 v189, 0, v205
  v_cvt_pk_bf16_f32 v190, 0, v206
  v_cvt_pk_bf16_f32 v191, 0, v207
  v_mul_f32 v184, s78, v184
  v_mul_f32 v185, s78, v185
  v_mul_f32 v186, s78, v186
  v_mul_f32 v187, s78, v187
  v_mul_f32 v188, s78, v188
  v_mul_f32 v189, s78, v189
  v_mul_f32 v190, s78, v190
  v_mul_f32 v191, s78, v191
  v_cvt_pk_bf16_f32 v184, 0, v184
  v_cvt_pk_bf16_f32 v185, 0, v185
  v_cvt_pk_bf16_f32 v186, 0, v186
  v_cvt_pk_bf16_f32 v187, 0, v187
  v_cvt_pk_bf16_f32 v188, 0, v188
  v_cvt_pk_bf16_f32 v189, 0, v189
  v_cvt_pk_bf16_f32 v190, 0, v190
  v_cvt_pk_bf16_f32 v191, 0, v191
  v_max3_f32 v24, v24, v184, v185
  v_max3_f32 v24, v24, v186, v187
  v_max3_f32 v24, v24, v188, v189
  v_max3_f32 v24, v24, v190, v191
  s_waitcnt vmcnt(4)
  s_mov_b32 s72, 0x20000
  buffer_load_dwordx4 a[128:131], v16, s[36:39], s72 offen offset:0 nt
  buffer_load_dwordx4 a[132:135], v16, s[36:39], s72 offen offset:256 nt
  buffer_load_dwordx4 a[136:139], v16, s[36:39], s72 offen offset:512 nt
  buffer_load_dwordx4 a[140:143], v16, s[36:39], s72 offen offset:768 nt
  s_waitcnt vmcnt(4)
  s_mov_b32 s72, 0x24000
  buffer_load_dwordx4 a[144:147], v16, s[36:39], s72 offen offset:0 nt
  buffer_load_dwordx4 a[148:151], v16, s[36:39], s72 offen offset:256 nt
  buffer_load_dwordx4 a[152:155], v16, s[36:39], s72 offen offset:512 nt
  buffer_load_dwordx4 a[156:159], v16, s[36:39], s72 offen offset:768 nt
  ds_read_b128 v[104:107], v12 offset:24576
  ds_read_b128 v[108:111], v13 offset:24576
  ds_read_b128 v[112:115], v14 offset:24576
  ds_read_b128 v[116:119], v15 offset:24576
  ds_read_b128 v[120:123], v12 offset:28672
  ds_read_b128 v[124:127], v13 offset:28672
  ds_read_b128 v[128:131], v14 offset:28672
  ds_read_b128 v[132:135], v15 offset:28672
  s_waitcnt lgkmcnt(7)
  v_mfma_f32_16x16x32_bf16 v[200:203], v[104:107], v[72:75], 0
  s_waitcnt lgkmcnt(6)
  v_mfma_f32_16x16x32_bf16 v[200:203], v[108:111], v[76:79], v[200:203]
  s_waitcnt lgkmcnt(5)
  v_mfma_f32_16x16x32_bf16 v[200:203], v[112:115], v[80:83], v[200:203]
  s_waitcnt lgkmcnt(4)
  v_mfma_f32_16x16x32_bf16 v[200:203], v[116:119], v[84:87], v[200:203]
  s_waitcnt lgkmcnt(3)
  v_mfma_f32_16x16x32_bf16 v[204:207], v[120:123], v[72:75], 0
  s_waitcnt lgkmcnt(2)
  v_mfma_f32_16x16x32_bf16 v[204:207], v[124:127], v[76:79], v[204:207]
  s_waitcnt lgkmcnt(1)
  v_mfma_f32_16x16x32_bf16 v[204:207], v[128:131], v[80:83], v[204:207]
  s_waitcnt lgkmcnt(0)
  v_mfma_f32_16x16x32_bf16 v[204:207], v[132:135], v[84:87], v[204:207]
  s_mov_b32 s78, 0x3db504f3
  v_cvt_pk_bf16_f32 v192, 0, v200
  v_cvt_pk_bf16_f32 v193, 0, v201
  v_cvt_pk_bf16_f32 v194, 0, v202
  v_cvt_pk_bf16_f32 v195, 0, v203
  s_nop 2
  v_cvt_pk_bf16_f32 v196, 0, v204
  v_cvt_pk_bf16_f32 v197, 0, v205
  v_cvt_pk_bf16_f32 v198, 0, v206
  v_cvt_pk_bf16_f32 v199, 0, v207
  v_mul_f32 v192, s78, v192
  v_mul_f32 v193, s78, v193
  v_mul_f32 v194, s78, v194
  v_mul_f32 v195, s78, v195
  v_mul_f32 v196, s78, v196
  v_mul_f32 v197, s78, v197
  v_mul_f32 v198, s78, v198
  v_mul_f32 v199, s78, v199
  v_cvt_pk_bf16_f32 v192, 0, v192
  v_cvt_pk_bf16_f32 v193, 0, v193
  v_cvt_pk_bf16_f32 v194, 0, v194
  v_cvt_pk_bf16_f32 v195, 0, v195
  v_cvt_pk_bf16_f32 v196, 0, v196
  v_cvt_pk_bf16_f32 v197, 0, v197
  v_cvt_pk_bf16_f32 v198, 0, v198
  v_cvt_pk_bf16_f32 v199, 0, v199
  v_max3_f32 v24, v24, v192, v193
  v_max3_f32 v24, v24, v194, v195
  v_max3_f32 v24, v24, v196, v197
  v_max3_f32 v24, v24, v198, v199
  v_mov_b32 v32, v24
  s_nop 1
  v_permlane16_swap_b32 v24, v32
  v_max_f32 v24, v24, v32
  v_mov_b32 v32, v24
  s_nop 1
  v_permlane32_swap_b32 v24, v32
  v_max_f32 v24, v24, v32
  v_mul_f32 v24, 0x3fb8aa3b, v24
  v_mov_b32 v25, 0
  v_mov_b32 v33, 0
  s_mov_b32 s78, 0x3fb8aa3b
  v_fma_f32 v136, v136, s78, -v24
  v_fma_f32 v137, v137, s78, -v24
  v_fma_f32 v138, v138, s78, -v24
  v_fma_f32 v139, v139, s78, -v24
  v_fma_f32 v140, v140, s78, -v24
  v_fma_f32 v141, v141, s78, -v24
  v_fma_f32 v142, v142, s78, -v24
  v_fma_f32 v143, v143, s78, -v24
  v_exp_f32 v136, v136
  v_exp_f32 v137, v137
  v_exp_f32 v138, v138
  v_exp_f32 v139, v139
  v_exp_f32 v140, v140
  v_exp_f32 v141, v141
  v_exp_f32 v142, v142
  v_exp_f32 v143, v143
  v_add_f32 v25, v25, v136
  v_add_f32 v33, v33, v137
  v_add_f32 v25, v25, v138
  v_add_f32 v33, v33, v139
  v_add_f32 v25, v25, v140
  v_add_f32 v33, v33, v141
  v_add_f32 v25, v25, v142
  v_add_f32 v33, v33, v143
  v_cvt_pk_bf16_f32 v136, v136, v137
  v_cvt_pk_bf16_f32 v137, v138, v139
  v_cvt_pk_bf16_f32 v138, v140, v141
  v_cvt_pk_bf16_f32 v139, v142, v143
  s_mov_b32 s78, 0x3fb8aa3b
  v_fma_f32 v144, v144, s78, -v24
  v_fma_f32 v145, v145, s78, -v24
  v_fma_f32 v146, v146, s78, -v24
  v_fma_f32 v147, v147, s78, -v24
  v_fma_f32 v148, v148, s78, -v24
  v_fma_f32 v149, v149, s78, -v24
  v_fma_f32 v150, v150, s78, -v24
  v_fma_f32 v151, v151, s78, -v24
  v_exp_f32 v144, v144
  v_exp_f32 v145, v145
  v_exp_f32 v146, v146
  v_exp_f32 v147, v147
  v_exp_f32 v148, v148
  v_exp_f32 v149, v149
  v_exp_f32 v150, v150
  v_exp_f32 v151, v151
  v_add_f32 v25, v25, v144
  v_add_f32 v33, v33, v145
  v_add_f32 v25, v25, v146
  v_add_f32 v33, v33, v147
  v_add_f32 v25, v25, v148
  v_add_f32 v33, v33, v149
  v_add_f32 v25, v25, v150
  v_add_f32 v33, v33, v151
  v_cvt_pk_bf16_f32 v144, v144, v145
  v_cvt_pk_bf16_f32 v145, v146, v147
  v_cvt_pk_bf16_f32 v146, v148, v149
  v_cvt_pk_bf16_f32 v147, v150, v151
  s_waitcnt vmcnt(4)
  s_mov_b32 s72, 0x28000
  buffer_load_dwordx4 a[160:163], v16, s[36:39], s72 offen offset:0 nt
  buffer_load_dwordx4 a[164:167], v16, s[36:39], s72 offen offset:256 nt
  buffer_load_dwordx4 a[168:171], v16, s[36:39], s72 offen offset:512 nt
  buffer_load_dwordx4 a[172:175], v16, s[36:39], s72 offen offset:768 nt
  s_mov_b32 s78, 0x3fb8aa3b
  v_fma_f32 v152, v152, s78, -v24
  v_fma_f32 v153, v153, s78, -v24
  v_fma_f32 v154, v154, s78, -v24
  v_fma_f32 v155, v155, s78, -v24
  v_fma_f32 v156, v156, s78, -v24
  v_fma_f32 v157, v157, s78, -v24
  v_fma_f32 v158, v158, s78, -v24
  v_fma_f32 v159, v159, s78, -v24
  v_exp_f32 v152, v152
  v_exp_f32 v153, v153
  v_exp_f32 v154, v154
  v_exp_f32 v155, v155
  v_exp_f32 v156, v156
  v_exp_f32 v157, v157
  v_exp_f32 v158, v158
  v_exp_f32 v159, v159
  v_add_f32 v25, v25, v152
  v_add_f32 v33, v33, v153
  v_add_f32 v25, v25, v154
  v_add_f32 v33, v33, v155
  v_add_f32 v25, v25, v156
  v_add_f32 v33, v33, v157
  v_add_f32 v25, v25, v158
  v_add_f32 v33, v33, v159
  v_cvt_pk_bf16_f32 v152, v152, v153
  v_cvt_pk_bf16_f32 v153, v154, v155
  v_cvt_pk_bf16_f32 v154, v156, v157
  v_cvt_pk_bf16_f32 v155, v158, v159
  s_mov_b32 s78, 0x3fb8aa3b
  v_fma_f32 v160, v160, s78, -v24
  v_fma_f32 v161, v161, s78, -v24
  v_fma_f32 v162, v162, s78, -v24
  v_fma_f32 v163, v163, s78, -v24
  v_fma_f32 v164, v164, s78, -v24
  v_fma_f32 v165, v165, s78, -v24
  v_fma_f32 v166, v166, s78, -v24
  v_fma_f32 v167, v167, s78, -v24
  v_exp_f32 v160, v160
  v_exp_f32 v161, v161
  v_exp_f32 v162, v162
  v_exp_f32 v163, v163
  v_exp_f32 v164, v164
  v_exp_f32 v165, v165
  v_exp_f32 v166, v166
  v_exp_f32 v167, v167
  v_add_f32 v25, v25, v160
  v_add_f32 v33, v33, v161
  v_add_f32 v25, v25, v162
  v_add_f32 v33, v33, v163
  v_add_f32 v25, v25, v164
  v_add_f32 v33, v33, v165
  v_add_f32 v25, v25, v166
  v_add_f32 v33, v33, v167
  v_cvt_pk_bf16_f32 v160, v160, v161
  v_cvt_pk_bf16_f32 v161, v162, v163
  v_cvt_pk_bf16_f32 v162, v164, v165
  v_cvt_pk_bf16_f32 v163, v166, v167
  s_mov_b32 s78, 0x3fb8aa3b
  v_fma_f32 v168, v168, s78, -v24
  v_fma_f32 v169, v169, s78, -v24
  v_fma_f32 v170, v170, s78, -v24
  v_fma_f32 v171, v171, s78, -v24
  v_fma_f32 v172, v172, s78, -v24
  v_fma_f32 v173, v173, s78, -v24
  v_fma_f32 v174, v174, s78, -v24
  v_fma_f32 v175, v175, s78, -v24
  v_exp_f32 v168, v168
  v_exp_f32 v169, v169
  v_exp_f32 v170, v170
  v_exp_f32 v171, v171
  v_exp_f32 v172, v172
  v_exp_f32 v173, v173
  v_exp_f32 v174, v174
  v_exp_f32 v175, v175
  v_add_f32 v25, v25, v168
  v_add_f32 v33, v33, v169
  v_add_f32 v25, v25, v170
  v_add_f32 v33, v33, v171
  v_add_f32 v25, v25, v172
  v_add_f32 v33, v33, v173
  v_add_f32 v25, v25, v174
  v_add_f32 v33, v33, v175
  v_cvt_pk_bf16_f32 v168, v168, v169
  v_cvt_pk_bf16_f32 v169, v170, v171
  v_cvt_pk_bf16_f32 v170, v172, v173
  v_cvt_pk_bf16_f32 v171, v174, v175
  s_mov_b32 s78, 0x3fb8aa3b
  v_fma_f32 v176, v176, s78, -v24
  v_fma_f32 v177, v177, s78, -v24
  v_fma_f32 v178, v178, s78, -v24
  v_fma_f32 v179, v179, s78, -v24
  v_fma_f32 v180, v180, s78, -v24
  v_fma_f32 v181, v181, s78, -v24
  v_fma_f32 v182, v182, s78, -v24
  v_fma_f32 v183, v183, s78, -v24
  v_exp_f32 v176, v176
  v_exp_f32 v177, v177
  v_exp_f32 v178, v178
  v_exp_f32 v179, v179
  v_exp_f32 v180, v180
  v_exp_f32 v181, v181
  v_exp_f32 v182, v182
  v_exp_f32 v183, v183
  v_add_f32 v25, v25, v176
  v_add_f32 v33, v33, v177
  v_add_f32 v25, v25, v178
  v_add_f32 v33, v33, v179
  v_add_f32 v25, v25, v180
  v_add_f32 v33, v33, v181
  v_add_f32 v25, v25, v182
  v_add_f32 v33, v33, v183
  v_cvt_pk_bf16_f32 v176, v176, v177
  v_cvt_pk_bf16_f32 v177, v178, v179
  v_cvt_pk_bf16_f32 v178, v180, v181
  v_cvt_pk_bf16_f32 v179, v182, v183
  s_waitcnt vmcnt(4)
  s_mov_b32 s72, 0x2c000
  buffer_load_dwordx4 a[176:179], v16, s[36:39], s72 offen offset:0 nt
  buffer_load_dwordx4 a[180:183], v16, s[36:39], s72 offen offset:256 nt
  buffer_load_dwordx4 a[184:187], v16, s[36:39], s72 offen offset:512 nt
  buffer_load_dwordx4 a[188:191], v16, s[36:39], s72 offen offset:768 nt
  s_mov_b32 s78, 0x3fb8aa3b
  v_fma_f32 v184, v184, s78, -v24
  v_fma_f32 v185, v185, s78, -v24
  v_fma_f32 v186, v186, s78, -v24
  v_fma_f32 v187, v187, s78, -v24
  v_fma_f32 v188, v188, s78, -v24
  v_fma_f32 v189, v189, s78, -v24
  v_fma_f32 v190, v190, s78, -v24
  v_fma_f32 v191, v191, s78, -v24
  v_exp_f32 v184, v184
  v_exp_f32 v185, v185
  v_exp_f32 v186, v186
  v_exp_f32 v187, v187
  v_exp_f32 v188, v188
  v_exp_f32 v189, v189
  v_exp_f32 v190, v190
  v_exp_f32 v191, v191
  v_add_f32 v25, v25, v184
  v_add_f32 v33, v33, v185
  v_add_f32 v25, v25, v186
  v_add_f32 v33, v33, v187
  v_add_f32 v25, v25, v188
  v_add_f32 v33, v33, v189
  v_add_f32 v25, v25, v190
  v_add_f32 v33, v33, v191
  v_cvt_pk_bf16_f32 v184, v184, v185
  v_cvt_pk_bf16_f32 v185, v186, v187
  v_cvt_pk_bf16_f32 v186, v188, v189
  v_cvt_pk_bf16_f32 v187, v190, v191
  s_mov_b32 s78, 0x3fb8aa3b
  v_fma_f32 v192, v192, s78, -v24
  v_fma_f32 v193, v193, s78, -v24
  v_fma_f32 v194, v194, s78, -v24
  v_fma_f32 v195, v195, s78, -v24
  v_fma_f32 v196, v196, s78, -v24
  v_fma_f32 v197, v197, s78, -v24
  v_fma_f32 v198, v198, s78, -v24
  v_fma_f32 v199, v199, s78, -v24
  v_exp_f32 v192, v192
  v_exp_f32 v193, v193
  v_exp_f32 v194, v194
  v_exp_f32 v195, v195
  v_exp_f32 v196, v196
  v_exp_f32 v197, v197
  v_exp_f32 v198, v198
  v_exp_f32 v199, v199
  v_add_f32 v25, v25, v192
  v_add_f32 v33, v33, v193
  v_add_f32 v25, v25, v194
  v_add_f32 v33, v33, v195
  v_add_f32 v25, v25, v196
  v_add_f32 v33, v33, v197
  v_add_f32 v25, v25, v198
  v_add_f32 v33, v33, v199
  v_cvt_pk_bf16_f32 v192, v192, v193
  v_cvt_pk_bf16_f32 v193, v194, v195
  v_cvt_pk_bf16_f32 v194, v196, v197
  v_cvt_pk_bf16_f32 v195, v198, v199
  v_add_f32 v25, v25, v33
  v_mov_b32 v32, v25
  s_nop 1
  v_permlane16_swap_b32 v25, v32
  v_add_f32 v25, v25, v32
  v_mov_b32 v32, v25
  s_nop 1
  v_permlane32_swap_b32 v25, v32
  v_add_f32 v25, v25, v32
  s_lshl_b32 s70, s3, 3
  s_add_u32 s70, s70, 149504
  v_lshlrev_b32 v32, 3, v1
  v_add_u32 v32, s70, v32
  s_mov_b64 exec, 0x1111
  ds_write_b64 v32, v[24:25]
  s_mov_b64 exec, -1
  v_perm_b32 v104, v136, v136, v20
  v_perm_b32 v105, v136, v136, v21
  v_perm_b32 v106, v136, v136, v22
  v_perm_b32 v107, v136, v136, v23
  v_perm_b32 v108, v137, v137, v20
  v_perm_b32 v109, v137, v137, v21
  v_perm_b32 v110, v137, v137, v22
  v_perm_b32 v111, v137, v137, v23
  v_perm_b32 v112, v138, v138, v20
  v_perm_b32 v113, v138, v138, v21
  v_perm_b32 v114, v138, v138, v22
  v_perm_b32 v115, v138, v138, v23
  v_perm_b32 v116, v139, v139, v20
  v_perm_b32 v117, v139, v139, v21
  v_perm_b32 v118, v139, v139, v22
  v_perm_b32 v119, v139, v139, v23
  v_mfma_f32_16x16x16_bf16 v[208:211], v[104:105], a[0:1], 0
  v_mfma_f32_16x16x16_bf16 v[212:215], v[104:105], a[2:3], 0
  v_mfma_f32_16x16x16_bf16 v[208:211], v[106:107], a[4:5], v[208:211]
  v_mfma_f32_16x16x16_bf16 v[212:215], v[106:107], a[6:7], v[212:215]
  v_mfma_f32_16x16x16_bf16 v[208:211], v[108:109], a[8:9], v[208:211]
  v_mfma_f32_16x16x16_bf16 v[212:215], v[108:109], a[10:11], v[212:215]
  v_mfma_f32_16x16x16_bf16 v[208:211], v[110:111], a[12:13], v[208:211]
  v_mfma_f32_16x16x16_bf16 v[212:215], v[110:111], a[14:15], v[212:215]
  v_mfma_f32_16x16x16_bf16 v[208:211], v[112:113], a[16:17], v[208:211]
  v_mfma_f32_16x16x16_bf16 v[212:215], v[112:113], a[18:19], v[212:215]
  v_mfma_f32_16x16x16_bf16 v[208:211], v[114:115], a[20:21], v[208:211]
  v_mfma_f32_16x16x16_bf16 v[212:215], v[114:115], a[22:23], v[212:215]
  v_mfma_f32_16x16x16_bf16 v[208:211], v[116:117], a[24:25], v[208:211]
  v_mfma_f32_16x16x16_bf16 v[212:215], v[116:117], a[26:27], v[212:215]
  v_mfma_f32_16x16x16_bf16 v[208:211], v[118:119], a[28:29], v[208:211]
  v_mfma_f32_16x16x16_bf16 v[212:215], v[118:119], a[30:31], v[212:215]
  s_waitcnt vmcnt(4)
  s_mov_b32 s72, 0x30000
  buffer_load_dwordx4 a[192:195], v16, s[36:39], s72 offen offset:0 nt
  buffer_load_dwordx4 a[196:199], v16, s[36:39], s72 offen offset:256 nt
  buffer_load_dwordx4 a[200:203], v16, s[36:39], s72 offen offset:512 nt
  buffer_load_dwordx4 a[204:207], v16, s[36:39], s72 offen offset:768 nt
  v_perm_b32 v120, v144, v144, v20
  v_perm_b32 v121, v144, v144, v21
  v_perm_b32 v122, v144, v144, v22
  v_perm_b32 v123, v144, v144, v23
  v_perm_b32 v124, v145, v145, v20
  v_perm_b32 v125, v145, v145, v21
  v_perm_b32 v126, v145, v145, v22
  v_perm_b32 v127, v145, v145, v23
  v_perm_b32 v128, v146, v146, v20
  v_perm_b32 v129, v146, v146, v21
  v_perm_b32 v130, v146, v146, v22
  v_perm_b32 v131, v146, v146, v23
  v_perm_b32 v132, v147, v147, v20
  v_perm_b32 v133, v147, v147, v21
  v_perm_b32 v134, v147, v147, v22
  v_perm_b32 v135, v147, v147, v23
  v_mfma_f32_16x16x16_bf16 v[208:211], v[120:121], a[32:33], v[208:211]
  v_mfma_f32_16x16x16_bf16 v[212:215], v[120:121], a[34:35], v[212:215]
  v_mfma_f32_16x16x16_bf16 v[208:211], v[122:123], a[36:37], v[208:211]
  v_mfma_f32_16x16x16_bf16 v[212:215], v[122:123], a[38:39], v[212:215]
  v_mfma_f32_16x16x16_bf16 v[208:211], v[124:125], a[40:41], v[208:211]
  v_mfma_f32_16x16x16_bf16 v[212:215], v[124:125], a[42:43], v[212:215]
  v_mfma_f32_16x16x16_bf16 v[208:211], v[126:127], a[44:45], v[208:211]
  v_mfma_f32_16x16x16_bf16 v[212:215], v[126:127], a[46:47], v[212:215]
  v_mfma_f32_16x16x16_bf16 v[208:211], v[128:129], a[48:49], v[208:211]
  v_mfma_f32_16x16x16_bf16 v[212:215], v[128:129], a[50:51], v[212:215]
  v_mfma_f32_16x16x16_bf16 v[208:211], v[130:131], a[52:53], v[208:211]
  v_mfma_f32_16x16x16_bf16 v[212:215], v[130:131], a[54:55], v[212:215]
  v_mfma_f32_16x16x16_bf16 v[208:211], v[132:133], a[56:57], v[208:211]
  v_mfma_f32_16x16x16_bf16 v[212:215], v[132:133], a[58:59], v[212:215]
  v_mfma_f32_16x16x16_bf16 v[208:211], v[134:135], a[60:61], v[208:211]
  v_mfma_f32_16x16x16_bf16 v[212:215], v[134:135], a[62:63], v[212:215]
  v_perm_b32 v104, v152, v152, v20
  v_perm_b32 v105, v152, v152, v21
  v_perm_b32 v106, v152, v152, v22
  v_perm_b32 v107, v152, v152, v23
  v_perm_b32 v108, v153, v153, v20
  v_perm_b32 v109, v153, v153, v21
  v_perm_b32 v110, v153, v153, v22
  v_perm_b32 v111, v153, v153, v23
  v_perm_b32 v112, v154, v154, v20
  v_perm_b32 v113, v154, v154, v21
  v_perm_b32 v114, v154, v154, v22
  v_perm_b32 v115, v154, v154, v23
  v_perm_b32 v116, v155, v155, v20
  v_perm_b32 v117, v155, v155, v21
  v_perm_b32 v118, v155, v155, v22
  v_perm_b32 v119, v155, v155, v23
  v_mfma_f32_16x16x16_bf16 v[208:211], v[104:105], a[64:65], v[208:211]
  v_mfma_f32_16x16x16_bf16 v[212:215], v[104:105], a[66:67], v[212:215]
  v_mfma_f32_16x16x16_bf16 v[208:211], v[106:107], a[68:69], v[208:211]
  v_mfma_f32_16x16x16_bf16 v[212:215], v[106:107], a[70:71], v[212:215]
  v_mfma_f32_16x16x16_bf16 v[208:211], v[108:109], a[72:73], v[208:211]
  v_mfma_f32_16x16x16_bf16 v[212:215], v[108:109], a[74:75], v[212:215]
  v_mfma_f32_16x16x16_bf16 v[208:211], v[110:111], a[76:77], v[208:211]
  v_mfma_f32_16x16x16_bf16 v[212:215], v[110:111], a[78:79], v[212:215]
  v_mfma_f32_16x16x16_bf16 v[208:211], v[112:113], a[80:81], v[208:211]
  v_mfma_f32_16x16x16_bf16 v[212:215], v[112:113], a[82:83], v[212:215]
  v_mfma_f32_16x16x16_bf16 v[208:211], v[114:115], a[84:85], v[208:211]
  v_mfma_f32_16x16x16_bf16 v[212:215], v[114:115], a[86:87], v[212:215]
  v_mfma_f32_16x16x16_bf16 v[208:211], v[116:117], a[88:89], v[208:211]
  v_mfma_f32_16x16x16_bf16 v[212:215], v[116:117], a[90:91], v[212:215]
  v_mfma_f32_16x16x16_bf16 v[208:211], v[118:119], a[92:93], v[208:211]
  v_mfma_f32_16x16x16_bf16 v[212:215], v[118:119], a[94:95], v[212:215]
  s_waitcnt vmcnt(4)
  s_mov_b32 s72, 0x34000
  buffer_load_dwordx4 a[208:211], v16, s[36:39], s72 offen offset:0 nt
  buffer_load_dwordx4 a[212:215], v16, s[36:39], s72 offen offset:256 nt
  buffer_load_dwordx4 a[216:219], v16, s[36:39], s72 offen offset:512 nt
  buffer_load_dwordx4 a[220:223], v16, s[36:39], s72 offen offset:768 nt
  v_perm_b32 v120, v160, v160, v20
  v_perm_b32 v121, v160, v160, v21
  v_perm_b32 v122, v160, v160, v22
  v_perm_b32 v123, v160, v160, v23
  v_perm_b32 v124, v161, v161, v20
  v_perm_b32 v125, v161, v161, v21
  v_perm_b32 v126, v161, v161, v22
  v_perm_b32 v127, v161, v161, v23
  v_perm_b32 v128, v162, v162, v20
  v_perm_b32 v129, v162, v162, v21
  v_perm_b32 v130, v162, v162, v22
  v_perm_b32 v131, v162, v162, v23
  v_perm_b32 v132, v163, v163, v20
  v_perm_b32 v133, v163, v163, v21
  v_perm_b32 v134, v163, v163, v22
  v_perm_b32 v135, v163, v163, v23
  v_mfma_f32_16x16x16_bf16 v[208:211], v[120:121], a[96:97], v[208:211]
  v_mfma_f32_16x16x16_bf16 v[212:215], v[120:121], a[98:99], v[212:215]
  v_mfma_f32_16x16x16_bf16 v[208:211], v[122:123], a[100:101], v[208:211]
  v_mfma_f32_16x16x16_bf16 v[212:215], v[122:123], a[102:103], v[212:215]
  v_mfma_f32_16x16x16_bf16 v[208:211], v[124:125], a[104:105], v[208:211]
  v_mfma_f32_16x16x16_bf16 v[212:215], v[124:125], a[106:107], v[212:215]
  v_mfma_f32_16x16x16_bf16 v[208:211], v[126:127], a[108:109], v[208:211]
  v_mfma_f32_16x16x16_bf16 v[212:215], v[126:127], a[110:111], v[212:215]
  v_mfma_f32_16x16x16_bf16 v[208:211], v[128:129], a[112:113], v[208:211]
  v_mfma_f32_16x16x16_bf16 v[212:215], v[128:129], a[114:115], v[212:215]
  v_mfma_f32_16x16x16_bf16 v[208:211], v[130:131], a[116:117], v[208:211]
  v_mfma_f32_16x16x16_bf16 v[212:215], v[130:131], a[118:119], v[212:215]
  v_mfma_f32_16x16x16_bf16 v[208:211], v[132:133], a[120:121], v[208:211]
  v_mfma_f32_16x16x16_bf16 v[212:215], v[132:133], a[122:123], v[212:215]
  v_mfma_f32_16x16x16_bf16 v[208:211], v[134:135], a[124:125], v[208:211]
  v_mfma_f32_16x16x16_bf16 v[212:215], v[134:135], a[126:127], v[212:215]
  v_perm_b32 v104, v168, v168, v20
  v_perm_b32 v105, v168, v168, v21
  v_perm_b32 v106, v168, v168, v22
  v_perm_b32 v107, v168, v168, v23
  v_perm_b32 v108, v169, v169, v20
  v_perm_b32 v109, v169, v169, v21
  v_perm_b32 v110, v169, v169, v22
  v_perm_b32 v111, v169, v169, v23
  v_perm_b32 v112, v170, v170, v20
  v_perm_b32 v113, v170, v170, v21
  v_perm_b32 v114, v170, v170, v22
  v_perm_b32 v115, v170, v170, v23
  v_perm_b32 v116, v171, v171, v20
  v_perm_b32 v117, v171, v171, v21
  v_perm_b32 v118, v171, v171, v22
  v_perm_b32 v119, v171, v171, v23
  v_mfma_f32_16x16x16_bf16 v[208:211], v[104:105], a[128:129], v[208:211]
  v_mfma_f32_16x16x16_bf16 v[212:215], v[104:105], a[130:131], v[212:215]
  v_mfma_f32_16x16x16_bf16 v[208:211], v[106:107], a[132:133], v[208:211]
  v_mfma_f32_16x16x16_bf16 v[212:215], v[106:107], a[134:135], v[212:215]
  v_mfma_f32_16x16x16_bf16 v[208:211], v[108:109], a[136:137], v[208:211]
  v_mfma_f32_16x16x16_bf16 v[212:215], v[108:109], a[138:139], v[212:215]
  v_mfma_f32_16x16x16_bf16 v[208:211], v[110:111], a[140:141], v[208:211]
  v_mfma_f32_16x16x16_bf16 v[212:215], v[110:111], a[142:143], v[212:215]
  v_mfma_f32_16x16x16_bf16 v[208:211], v[112:113], a[144:145], v[208:211]
  v_mfma_f32_16x16x16_bf16 v[212:215], v[112:113], a[146:147], v[212:215]
  v_mfma_f32_16x16x16_bf16 v[208:211], v[114:115], a[148:149], v[208:211]
  v_mfma_f32_16x16x16_bf16 v[212:215], v[114:115], a[150:151], v[212:215]
  v_mfma_f32_16x16x16_bf16 v[208:211], v[116:117], a[152:153], v[208:211]
  v_mfma_f32_16x16x16_bf16 v[212:215], v[116:117], a[154:155], v[212:215]
  v_mfma_f32_16x16x16_bf16 v[208:211], v[118:119], a[156:157], v[208:211]
  v_mfma_f32_16x16x16_bf16 v[212:215], v[118:119], a[158:159], v[212:215]
  s_waitcnt vmcnt(4)
  s_mov_b32 s72, 0x38000
  buffer_load_dwordx4 a[224:227], v16, s[36:39], s72 offen offset:0 nt
  buffer_load_dwordx4 a[228:231], v16, s[36:39], s72 offen offset:256 nt
  buffer_load_dwordx4 a[232:235], v16, s[36:39], s72 offen offset:512 nt
  buffer_load_dwordx4 a[236:239], v16, s[36:39], s72 offen offset:768 nt
  v_perm_b32 v120, v176, v176, v20
  v_perm_b32 v121, v176, v176, v21
  v_perm_b32 v122, v176, v176, v22
  v_perm_b32 v123, v176, v176, v23
  v_perm_b32 v124, v177, v177, v20
  v_perm_b32 v125, v177, v177, v21
  v_perm_b32 v126, v177, v177, v22
  v_perm_b32 v127, v177, v177, v23
  v_perm_b32 v128, v178, v178, v20
  v_perm_b32 v129, v178, v178, v21
  v_perm_b32 v130, v178, v178, v22
  v_perm_b32 v131, v178, v178, v23
  v_perm_b32 v132, v179, v179, v20
  v_perm_b32 v133, v179, v179, v21
  v_perm_b32 v134, v179, v179, v22
  v_perm_b32 v135, v179, v179, v23
  v_mfma_f32_16x16x16_bf16 v[208:211], v[120:121], a[160:161], v[208:211]
  v_mfma_f32_16x16x16_bf16 v[212:215], v[120:121], a[162:163], v[212:215]
  v_mfma_f32_16x16x16_bf16 v[208:211], v[122:123], a[164:165], v[208:211]
  v_mfma_f32_16x16x16_bf16 v[212:215], v[122:123], a[166:167], v[212:215]
  v_mfma_f32_16x16x16_bf16 v[208:211], v[124:125], a[168:169], v[208:211]
  v_mfma_f32_16x16x16_bf16 v[212:215], v[124:125], a[170:171], v[212:215]
  v_mfma_f32_16x16x16_bf16 v[208:211], v[126:127], a[172:173], v[208:211]
  v_mfma_f32_16x16x16_bf16 v[212:215], v[126:127], a[174:175], v[212:215]
  v_mfma_f32_16x16x16_bf16 v[208:211], v[128:129], a[176:177], v[208:211]
  v_mfma_f32_16x16x16_bf16 v[212:215], v[128:129], a[178:179], v[212:215]
  v_mfma_f32_16x16x16_bf16 v[208:211], v[130:131], a[180:181], v[208:211]
  v_mfma_f32_16x16x16_bf16 v[212:215], v[130:131], a[182:183], v[212:215]
  v_mfma_f32_16x16x16_bf16 v[208:211], v[132:133], a[184:185], v[208:211]
  v_mfma_f32_16x16x16_bf16 v[212:215], v[132:133], a[186:187], v[212:215]
  v_mfma_f32_16x16x16_bf16 v[208:211], v[134:135], a[188:189], v[208:211]
  v_mfma_f32_16x16x16_bf16 v[212:215], v[134:135], a[190:191], v[212:215]
  s_waitcnt vmcnt(4)
  s_mov_b32 s72, 0x3c000
  buffer_load_dwordx4 a[240:243], v16, s[36:39], s72 offen offset:0 nt
  buffer_load_dwordx4 a[244:247], v16, s[36:39], s72 offen offset:256 nt
  buffer_load_dwordx4 a[248:251], v16, s[36:39], s72 offen offset:512 nt
  buffer_load_dwordx4 a[252:255], v16, s[36:39], s72 offen offset:768 nt
L_tail:
  s_waitcnt lgkmcnt(0)
  s_barrier
  s_lshl_b32 s70, s3, 5
  s_add_u32 s70, s70, 149504
  v_mov_b32 v32, s70
  ds_read_b128 v[72:75], v32
  ds_read_b128 v[76:79], v32 offset:16
  v_mov_b32 v33, 149632
  ds_read_b128 v[80:83], v33
  ds_read_b128 v[84:87], v33 offset:16
  s_waitcnt lgkmcnt(0)
  v_max3_f32 v220, v72, v74, v76
  v_max_f32 v220, v220, v78
  v_sub_f32 v216, v72, v220
  v_sub_f32 v217, v74, v220
  v_sub_f32 v218, v76, v220
  v_sub_f32 v219, v78, v220
  v_exp_f32 v216, v216
  v_exp_f32 v217, v217
  v_exp_f32 v218, v218
  v_exp_f32 v219, v219
  v_mul_f32 v221, v216, v73
  v_fmac_f32 v221, v217, v75
  v_fmac_f32 v221, v218, v77
  v_fmac_f32 v221, v219, v79
  v_rcp_f32 v222, v221
  v_log_f32 v221, v221
  v_mul_f32 v216, v216, v222
  v_mul_f32 v217, v217, v222
  v_mul_f32 v218, v218, v222
  v_mul_f32 v219, v219, v222
  v_add_f32 v38, v220, v221
  v_xor_b32 v39, v38, v2
  v_add_f32 v80, v80, v82
  v_add_f32 v84, v84, v86
  v_add_f32 v81, v81, v83
  v_add_f32 v85, v85, v87
  v_lshlrev_b32 v29, 16, v29
  v_add_f32 v26, v80, v84
  v_add_f32 v27, v81, v85
  v_cvt_pk_bf16_f32 v26, 0, v26
  v_cvt_pk_bf16_f32 v27, 0, v27
  v_add_f32 v26, v26, v29
  v_add_f32 v27, v27, v29
  v_cvt_pk_bf16_f32 v26, 0, v26
  v_cvt_pk_bf16_f32 v27, 0, v27
  v_lshlrev_b32 v222, 16, v28
  v_and_b32 v223, 0xffff0000, v28
  s_mov_b32 s72, 0
  buffer_load_dword v224, v4, s[44:47], s72 offen offset:0 nt
  buffer_load_dword v225, v4, s[44:47], s72 offen offset:1024 nt
  buffer_load_dword v226, v4, s[44:47], s72 offen offset:2048 nt
  buffer_load_dword v227, v4, s[44:47], s72 offen offset:3072 nt
  s_mov_b32 s72, 4096
  buffer_load_dword v228, v4, s[44:47], s72 offen offset:0 nt
  buffer_load_dword v229, v4, s[44:47], s72 offen offset:1024 nt
  buffer_load_dword v230, v4, s[44:47], s72 offen offset:2048 nt
  buffer_load_dword v231, v4, s[44:47], s72 offen offset:3072 nt
  s_mov_b32 s72, 8192
  buffer_load_dword v232, v4, s[44:47], s72 offen offset:0 nt
  buffer_load_dword v233, v4, s[44:47], s72 offen offset:1024 nt
  buffer_load_dword v234, v4, s[44:47], s72 offen offset:2048 nt
  buffer_load_dword v235, v4, s[44:47], s72 offen offset:3072 nt
  s_mov_b32 s72, 12288
  buffer_load_dword v236, v4, s[44:47], s72 offen offset:0 nt
  buffer_load_dword v237, v4, s[44:47], s72 offen offset:1024 nt
  buffer_load_dword v238, v4, s[44:47], s72 offen offset:2048 nt
  buffer_load_dword v239, v4, s[44:47], s72 offen offset:3072 nt
  v_perm_b32 v104, v184, v184, v20
  v_perm_b32 v105, v184, v184, v21
  v_perm_b32 v106, v184, v184, v22
  v_perm_b32 v107, v184, v184, v23
  v_perm_b32 v108, v185, v185, v20
  v_perm_b32 v109, v185, v185, v21
  v_perm_b32 v110, v185, v185, v22
  v_perm_b32 v111, v185, v185, v23
  v_perm_b32 v112, v186, v186, v20
  v_perm_b32 v113, v186, v186, v21
  v_perm_b32 v114, v186, v186, v22
  v_perm_b32 v115, v186, v186, v23
  v_perm_b32 v116, v187, v187, v20
  v_perm_b32 v117, v187, v187, v21
  v_perm_b32 v118, v187, v187, v22
  v_perm_b32 v119, v187, v187, v23
  v_mfma_f32_16x16x16_bf16 v[208:211], v[104:105], a[192:193], v[208:211]
  v_mfma_f32_16x16x16_bf16 v[212:215], v[104:105], a[194:195], v[212:215]
  v_mfma_f32_16x16x16_bf16 v[208:211], v[106:107], a[196:197], v[208:211]
  v_mfma_f32_16x16x16_bf16 v[212:215], v[106:107], a[198:199], v[212:215]
  v_mfma_f32_16x16x16_bf16 v[208:211], v[108:109], a[200:201], v[208:211]
  v_mfma_f32_16x16x16_bf16 v[212:215], v[108:109], a[202:203], v[212:215]
  v_mfma_f32_16x16x16_bf16 v[208:211], v[110:111], a[204:205], v[208:211]
  v_mfma_f32_16x16x16_bf16 v[212:215], v[110:111], a[206:207], v[212:215]
  v_mfma_f32_16x16x16_bf16 v[208:211], v[112:113], a[208:209], v[208:211]
  v_mfma_f32_16x16x16_bf16 v[212:215], v[112:113], a[210:211], v[212:215]
  v_mfma_f32_16x16x16_bf16 v[208:211], v[114:115], a[212:213], v[208:211]
  v_mfma_f32_16x16x16_bf16 v[212:215], v[114:115], a[214:215], v[212:215]
  v_mfma_f32_16x16x16_bf16 v[208:211], v[116:117], a[216:217], v[208:211]
  v_mfma_f32_16x16x16_bf16 v[212:215], v[116:117], a[218:219], v[212:215]
  v_mfma_f32_16x16x16_bf16 v[208:211], v[118:119], a[220:221], v[208:211]
  v_mfma_f32_16x16x16_bf16 v[212:215], v[118:119], a[222:223], v[212:215]
  v_perm_b32 v120, v192, v192, v20
  v_perm_b32 v121, v192, v192, v21
  v_perm_b32 v122, v192, v192, v22
  v_perm_b32 v123, v192, v192, v23
  v_perm_b32 v124, v193, v193, v20
  v_perm_b32 v125, v193, v193, v21
  v_perm_b32 v126, v193, v193, v22
  v_perm_b32 v127, v193, v193, v23
  v_perm_b32 v128, v194, v194, v20
  v_perm_b32 v129, v194, v194, v21
  v_perm_b32 v130, v194, v194, v22
  v_perm_b32 v131, v194, v194, v23
  v_perm_b32 v132, v195, v195, v20
  v_perm_b32 v133, v195, v195, v21
  v_perm_b32 v134, v195, v195, v22
  v_perm_b32 v135, v195, v195, v23
  s_waitcnt vmcnt(23)
  v_mfma_f32_16x16x16_bf16 v[208:211], v[120:121], a[224:225], v[208:211]
  v_mfma_f32_16x16x16_bf16 v[212:215], v[120:121], a[226:227], v[212:215]
  s_waitcnt vmcnt(22)
  v_mfma_f32_16x16x16_bf16 v[208:211], v[122:123], a[228:229], v[208:211]
  v_mfma_f32_16x16x16_bf16 v[212:215], v[122:123], a[230:231], v[212:215]
  s_waitcnt vmcnt(21)
  v_mfma_f32_16x16x16_bf16 v[208:211], v[124:125], a[232:233], v[208:211]
  v_mfma_f32_16x16x16_bf16 v[212:215], v[124:125], a[234:235], v[212:215]
  s_waitcnt vmcnt(20)
  v_mfma_f32_16x16x16_bf16 v[208:211], v[126:127], a[236:237], v[208:211]
  v_mfma_f32_16x16x16_bf16 v[212:215], v[126:127], a[238:239], v[212:215]
  s_waitcnt vmcnt(19)
  v_mfma_f32_16x16x16_bf16 v[208:211], v[128:129], a[240:241], v[208:211]
  v_mfma_f32_16x16x16_bf16 v[212:215], v[128:129], a[242:243], v[212:215]
  s_waitcnt vmcnt(18)
  v_mfma_f32_16x16x16_bf16 v[208:211], v[130:131], a[244:245], v[208:211]
  v_mfma_f32_16x16x16_bf16 v[212:215], v[130:131], a[246:247], v[212:215]
  s_waitcnt vmcnt(17)
  v_mfma_f32_16x16x16_bf16 v[208:211], v[132:133], a[248:249], v[208:211]
  v_mfma_f32_16x16x16_bf16 v[212:215], v[132:133], a[250:251], v[212:215]
  s_waitcnt vmcnt(16)
  v_mfma_f32_16x16x16_bf16 v[208:211], v[134:135], a[252:253], v[208:211]
  v_mfma_f32_16x16x16_bf16 v[212:215], v[134:135], a[254:255], v[212:215]
  s_nop 6
  ds_write_b128 v56, v[208:211]
  ds_write_b128 v56, v[212:215] offset:1152
  s_waitcnt lgkmcnt(0)
  s_barrier
  ds_read_b64 v[72:73], v57 offset:0
  ds_read_b64 v[74:75], v57 offset:2304
  ds_read_b64 v[76:77], v57 offset:4608
  ds_read_b64 v[78:79], v57 offset:6912
  s_mov_b32 s73, 0
  s_cmp_lg_u32 s31, 0
  s_waitcnt lgkmcnt(3)
  v_pk_mul_f32 v[36:37], v[72:73], v[216:217] op_sel_hi:[1,0]
  s_waitcnt lgkmcnt(2)
  v_pk_fma_f32 v[36:37], v[74:75], v[216:217], v[36:37] op_sel:[0,1,0] op_sel_hi:[1,1,1]
  s_waitcnt lgkmcnt(1)
  v_pk_fma_f32 v[36:37], v[76:77], v[218:219], v[36:37] op_sel_hi:[1,0,1]
  s_waitcnt lgkmcnt(0)
  v_pk_fma_f32 v[36:37], v[78:79], v[218:219], v[36:37] op_sel:[0,1,0] op_sel_hi:[1,1,1]
  v_bitop3_b32 v39, v39, v36, v37 bitop3:0x96
  s_cbranch_scc1 L_pslow
  buffer_store_dwordx4 v[36:39], v3, s[48:51], s75 offen
L_pback:
  v_mov_b32 v32, 0
  v_mov_b32 v33, 0
  v_mov_b32 v34, 0
  v_mov_b32 v35, 0
  buffer_load_dwordx4 v[72:75], v58, s[48:51], s52 offen sc1
  buffer_load_dwordx4 v[76:79], v58, s[48:51], s53 offen sc1
  buffer_load_dwordx4 v[80:83], v58, s[48:51], s54 offen sc1
  buffer_load_dwordx4 v[84:87], v58, s[48:51], s55 offen sc1
  s_waitcnt vmcnt(4)
  s_mov_b32 s78, 0x05040100
  s_mov_b32 s79, 0x07060302
  v_perm_b32 v40, v225, v224, s78
  v_perm_b32 v48, v225, v224, s79
  v_perm_b32 v41, v227, v226, s78
  v_perm_b32 v49, v227, v226, s79
  v_perm_b32 v42, v229, v228, s78
  v_perm_b32 v50, v229, v228, s79
  v_perm_b32 v43, v231, v230, s78
  v_perm_b32 v51, v231, v230, s79
  v_perm_b32 v44, v233, v232, s78
  v_perm_b32 v52, v233, v232, s79
  v_perm_b32 v45, v235, v234, s78
  v_perm_b32 v53, v235, v234, s79
  v_perm_b32 v46, v237, v236, s78
  v_perm_b32 v54, v237, v236, s79
  v_perm_b32 v47, v239, v238, s78
  v_perm_b32 v55, v239, v238, s79
L_pg:
  s_waitcnt vmcnt(0)
  v_bitop3_b32 v100, v72, v73, v74 bitop3:0x96
  v_bitop3_b32 v101, v76, v77, v78 bitop3:0x96
  v_bitop3_b32 v102, v80, v81, v82 bitop3:0x96
  v_bitop3_b32 v103, v84, v85, v86 bitop3:0x96
  v_bitop3_b32 v100, v100, v75, v2 bitop3:0x96
  v_bitop3_b32 v101, v101, v79, v2 bitop3:0x96
  v_bitop3_b32 v102, v102, v83, v2 bitop3:0x96
  v_bitop3_b32 v103, v103, v87, v2 bitop3:0x96
  v_max3_f32 v92, v74, v78, v82
  v_or3_b32 v94, v100, v101, v102
  v_max_f32 v92, v92, v86
  v_or_b32 v94, v94, v103
  v_cmp_ne_u32 vcc, 0, v94
  v_max_f32_dpp v92, v92, v92 row_ror:8 row_mask:0xf bank_mask:0xf
  v_mov_b32 v93, v92
  s_cbranch_vccnz L_pretry
L_pcont:
  s_cmp_lg_u32 s3, 1
  s_cbranch_scc1 L_noe
  buffer_load_dwordx4 v[136:139], v59, s[48:51], s57 offen sc1
L_noe:
  v_permlane16_swap_b32 v92, v93
  v_max_f32 v92, v92, v93
  v_mov_b32 v93, v92
  s_nop 1
  v_permlane32_swap_b32 v92, v93
  v_max_f32 v92, v92, v93
  v_sub_f32 v88, v74, v92
  v_sub_f32 v89, v78, v92
  v_sub_f32 v90, v82, v92
  v_sub_f32 v91, v86, v92
  v_exp_f32 v88, v88
  v_exp_f32 v89, v89
  v_exp_f32 v90, v90
  v_exp_f32 v91, v91
  v_pk_mul_f32 v[96:97], v[72:73], v[88:89] op_sel_hi:[1,0]
  v_add_f32 v98, v88, v89
  v_pk_fma_f32 v[96:97], v[76:77], v[88:89], v[96:97] op_sel:[0,1,0] op_sel_hi:[1,1,1]
  v_add_f32 v98, v98, v90
  v_pk_fma_f32 v[96:97], v[80:81], v[90:91], v[96:97] op_sel_hi:[1,0,1]
  v_add_f32 v98, v98, v91
  v_pk_fma_f32 v[96:97], v[84:85], v[90:91], v[96:97] op_sel:[0,1,0] op_sel_hi:[1,1,1]
  s_nop 0
  v_add_f32_dpp v98, v98, v98 row_ror:8 row_mask:0xf bank_mask:0xf
  v_add_f32_dpp v96, v96, v96 row_ror:8 row_mask:0xf bank_mask:0xf
  v_add_f32_dpp v97, v97, v97 row_ror:8 row_mask:0xf bank_mask:0xf
  v_mov_b32 v88, v98
  v_mov_b32 v89, v96
  v_mov_b32 v90, v97
  v_permlane16_swap_b32 v98, v88
  v_permlane16_swap_b32 v96, v89
  v_permlane16_swap_b32 v97, v90
  v_add_f32 v98, v98, v88
  v_add_f32 v96, v96, v89
  v_add_f32 v97, v97, v90
  v_mov_b32 v88, v98
  v_mov_b32 v89, v96
  v_mov_b32 v90, v97
  v_permlane32_swap_b32 v98, v88
  v_permlane32_swap_b32 v96, v89
  v_permlane32_swap_b32 v97, v90
  v_add_f32 v98, v98, v88
  v_add_f32 v96, v96, v89
  v_add_f32 v97, v97, v90
  v_rcp_f32 v98, v98
  s_nop 0
  v_pk_mul_f32 v[96:97], v[96:97], v[98:99] op_sel_hi:[1,0]
  v_cvt_pk_bf16_f32 v96, v96, v97
  s_nop 1
  v_dot2c_f32_bf16_dpp v32, v96, v40 row_newbcast:0 row_mask:0xf bank_mask:0xf
  v_dot2c_f32_bf16_dpp v33, v96, v48 row_newbcast:0 row_mask:0xf bank_mask:0xf
  v_dot2c_f32_bf16_dpp v34, v96, v41 row_newbcast:1 row_mask:0xf bank_mask:0xf
  v_dot2c_f32_bf16_dpp v35, v96, v49 row_newbcast:1 row_mask:0xf bank_mask:0xf
  v_dot2c_f32_bf16_dpp v32, v96, v42 row_newbcast:2 row_mask:0xf bank_mask:0xf
  v_dot2c_f32_bf16_dpp v33, v96, v50 row_newbcast:2 row_mask:0xf bank_mask:0xf
  v_dot2c_f32_bf16_dpp v34, v96, v43 row_newbcast:3 row_mask:0xf bank_mask:0xf
  v_dot2c_f32_bf16_dpp v35, v96, v51 row_newbcast:3 row_mask:0xf bank_mask:0xf
  v_dot2c_f32_bf16_dpp v32, v96, v44 row_newbcast:4 row_mask:0xf bank_mask:0xf
  v_dot2c_f32_bf16_dpp v33, v96, v52 row_newbcast:4 row_mask:0xf bank_mask:0xf
  v_dot2c_f32_bf16_dpp v34, v96, v45 row_newbcast:5 row_mask:0xf bank_mask:0xf
  v_dot2c_f32_bf16_dpp v35, v96, v53 row_newbcast:5 row_mask:0xf bank_mask:0xf
  v_dot2c_f32_bf16_dpp v32, v96, v46 row_newbcast:6 row_mask:0xf bank_mask:0xf
  v_dot2c_f32_bf16_dpp v33, v96, v54 row_newbcast:6 row_mask:0xf bank_mask:0xf
  v_dot2c_f32_bf16_dpp v34, v96, v47 row_newbcast:7 row_mask:0xf bank_mask:0xf
  v_dot2c_f32_bf16_dpp v35, v96, v55 row_newbcast:7 row_mask:0xf bank_mask:0xf
  s_nop 2
  v_pk_add_f32 v[32:33], v[32:33], v[34:35]
L_pok:
  ds_write_b64 v60, v[32:33]
  s_waitcnt lgkmcnt(0)
  s_barrier
  s_cmp_lg_u32 s3, 0
  s_cbranch_scc1 L_w1
  ds_read_b64 v[72:73], v60 offset:0
  ds_read_b64 v[74:75], v60 offset:512
  ds_read_b64 v[76:77], v60 offset:1024
  ds_read_b64 v[78:79], v60 offset:1536
  s_mov_b32 s73, 0
  s_waitcnt lgkmcnt(2)
  v_pk_add_f32 v[72:73], v[72:73], v[74:75]
  s_waitcnt lgkmcnt(0)
  v_pk_add_f32 v[76:77], v[76:77], v[78:79]
  v_pk_add_f32 v[32:33], v[72:73], v[76:77]
  v_bitop3_b32 v34, v32, v33, v2 bitop3:0x96
  buffer_store_dwordx4 v[32:35], v3, s[48:51], s56 offen sc1
  s_branch L_fin
L_w1:
  s_cmp_lg_u32 s3, 1
  s_cbranch_scc1 L_fin
  s_mov_b32 s73, 0
  s_lshl_b32 s70, s66, 2
  v_mov_b32 v80, s70
  buffer_load_dwordx4 v[136:139], v59, s[48:51], s57 offen sc1
L_og:
  s_waitcnt vmcnt(1)
  v_bitop3_b32 v92, v136, v137, v138 bitop3:0x96
  v_add_f32_dpp v72, v136, v136 row_ror:1 row_mask:0xf bank_mask:0xf
  v_add_f32_dpp v73, v137, v137 row_ror:1 row_mask:0xf bank_mask:0xf
  v_cmp_ne_u32 vcc, v92, v2
  v_add_f32_dpp v72, v72, v72 row_ror:2 row_mask:0xf bank_mask:0xf
  v_add_f32_dpp v73, v73, v73 row_ror:2 row_mask:0xf bank_mask:0xf
  s_cbranch_vccnz L_oretry
L_ocont:
  v_add_f32_dpp v72, v72, v72 row_ror:4 row_mask:0xf bank_mask:0xf
  v_add_f32_dpp v73, v73, v73 row_ror:4 row_mask:0xf bank_mask:0xf
  s_nop 0
  v_add_f32_dpp v72, v72, v72 row_ror:8 row_mask:0xf bank_mask:0xf
  v_add_f32_dpp v73, v73, v73 row_ror:8 row_mask:0xf bank_mask:0xf
  v_mov_b32 v88, v72
  v_mov_b32 v89, v73
  s_nop 0
  v_permlane16_swap_b32 v72, v88
  v_permlane16_swap_b32 v73, v89
  v_add_f32 v72, v72, v88
  v_add_f32 v73, v73, v89
  v_mov_b32 v88, v72
  v_mov_b32 v89, v73
  s_nop 0
  v_permlane32_swap_b32 v72, v88
  v_permlane32_swap_b32 v73, v89
  v_add_f32 v72, v72, v88
  v_add_f32 v73, v73, v89
  v_cvt_pk_bf16_f32 v72, 0, v72
  v_cvt_pk_bf16_f32 v73, 0, v73
  v_pk_add_f32 v[72:73], v[72:73], v[222:223]
  v_cvt_pk_bf16_f32 v72, 0, v72
  v_cvt_pk_bf16_f32 v73, 0, v73
  v_pk_add_f32 v[72:73], v[72:73], v[26:27]
  v_cvt_pk_bf16_f32 v72, v72, v73
L_ook:
  s_mov_b64 exec, 1
  global_store_dword v80, v72, s[24:25]
  s_cmp_lg_u32 s2, 0
  s_cbranch_scc1 L_fin
  buffer_store_dword v2, off, s[48:51], 0 nt
L_fin:
  s_endpgm
L_qretry:
  s_mov_b32 s73, 0
L_qr:
  buffer_load_dwordx4 v[88:91], v3, s[48:51], s74 offen sc1
  s_add_u32 s72, s74, 4096
  buffer_load_dwordx4 v[92:95], v3, s[48:51], s72 offen sc1
  s_add_u32 s72, s74, 8192
  buffer_load_dwordx4 v[96:99], v3, s[48:51], s72 offen sc1
  s_add_u32 s72, s74, 12288
  buffer_load_dwordx4 v[100:103], v3, s[48:51], s72 offen sc1
  s_lshl_b32 s72, s64, 8
  s_add_u32 s72, s72, 0x8000
  buffer_load_dwordx2 v[136:137], v138, s[48:51], s72 offen sc1
  s_waitcnt vmcnt(0)
  v_bitop3_b32 v104, v88, v89, v90 bitop3:0x96
  v_bitop3_b32 v105, v92, v93, v94 bitop3:0x96
  v_bitop3_b32 v106, v96, v97, v98 bitop3:0x96
  v_bitop3_b32 v107, v100, v101, v102 bitop3:0x96
  v_bitop3_b32 v104, v104, v91, v2 bitop3:0x96
  v_bitop3_b32 v105, v105, v95, v2 bitop3:0x96
  v_bitop3_b32 v106, v106, v99, v2 bitop3:0x96
  v_bitop3_b32 v107, v107, v103, v2 bitop3:0x96
  v_or3_b32 v32, v104, v105, v106
  v_bitop3_b32 v104, v136, v137, v2 bitop3:0x96
  v_or3_b32 v32, v32, v107, v104
  v_cmp_ne_u32 vcc, 0, v32
  s_cbranch_vccz L_qok
  s_add_u32 s73, s73, 1
  s_cmp_lt_u32 s73, 4000
  s_cbranch_scc1 L_qr
  s_branch L_qok
L_pretry:
  s_add_u32 s73, s73, 1
  s_cmp_ge_u32 s73, 4000
  s_cbranch_scc1 L_pcont
  s_mov_b64 exec, vcc
  buffer_load_dwordx4 v[72:75], v58, s[48:51], s52 offen sc1
  buffer_load_dwordx4 v[76:79], v58, s[48:51], s53 offen sc1
  buffer_load_dwordx4 v[80:83], v58, s[48:51], s54 offen sc1
  buffer_load_dwordx4 v[84:87], v58, s[48:51], s55 offen sc1
  s_mov_b64 exec, -1
  s_branch L_pg
L_oretry:
  s_add_u32 s73, s73, 1
  s_cmp_ge_u32 s73, 4000
  s_cbranch_scc1 L_ocont
  s_mov_b64 exec, vcc
  buffer_load_dwordx4 v[136:139], v59, s[48:51], s57 offen sc1
  s_mov_b64 exec, -1
  s_branch L_og
L_pslow:
  buffer_store_dwordx4 v[36:39], v3, s[48:51], s75 offen sc1
  s_branch L_pback
L_codeend:
  s_endpgm
.section .rodata,"a"
.p2align 6
.amdhsa_kernel parallel_sum__gqa_block_cached__mixer_token_mlp__decode_kernel
  .amdhsa_next_free_vgpr 512
  .amdhsa_next_free_sgpr 102
  .amdhsa_accum_offset 256
  .amdhsa_group_segment_fixed_size 0
  .amdhsa_kernarg_size 104
  .amdhsa_user_sgpr_count 2
  .amdhsa_user_sgpr_kernarg_segment_ptr 1
  .amdhsa_system_sgpr_workgroup_id_x 1
  .amdhsa_float_denorm_mode_32 3
.end_amdhsa_kernel
```
